```python
import torch

def _softmax(x, axis=-1):
    return torch.softmax(x, dim=axis)
def _gelu(x):
    return torch.nn.functional.gelu(x, approximate="tanh")
def _silu(x):
    return torch.nn.functional.silu(x)
def _sigmoid(x):
    return torch.sigmoid(x)
def _layernorm(x, axis=-1, eps=1e-5):
    m = x.mean(dim=axis, keepdim=True)
    v = x.var(dim=axis, keepdim=True, unbiased=False)
    return (x - m) / torch.sqrt(v + eps)
def _scatter_add(tgt, idx, src, axis=0):
    return tgt.clone().index_add_(axis, idx, src)
def _segment_sum(src, seg, n):
    out = torch.zeros((n,) + src.shape[1:], dtype=src.dtype)
    return out.index_add_(0, seg, src)
def _pad(x, pw):
    flat = tuple(v for pair in reversed(pw) for v in pair)
    return torch.nn.functional.pad(x, flat)

kernel_name = 'standalone__edge_featured_mpnn_gatedgcn__graph'

def setup_inputs():

    _w = (lambda a: (lambda t: t.to(torch.bfloat16) if t.is_floating_point() else t)(torch.as_tensor(a)))
    N, deg, D, De = 25000, 32, 64, max(16, 1)
    E = N * deg
    return {
        "x": _w((lambda *s: torch.randn(*s, dtype=torch.bfloat16) * 0.8)(N, D)),
        "e_attr": _w((lambda *s: torch.randn(*s, dtype=torch.bfloat16) * 0.8)(E, De)),
        "src": _w((lambda lo, hi, *s: torch.randint(lo, hi, s))(0, N, E).to(torch.int64)),
        "dst": _w((lambda lo, hi, *s: torch.randint(lo, hi, s))(0, N, E).to(torch.int64)),
        "w_a": _w((lambda *s: torch.randn(*s, dtype=torch.bfloat16) * 0.8)(D, D)),
        "w_b": _w((lambda *s: torch.randn(*s, dtype=torch.bfloat16) * 0.8)(D, D)),
        "w_c": _w((lambda *s: torch.randn(*s, dtype=torch.bfloat16) * 0.8)(De, D)),
        "w_u": _w((lambda *s: torch.randn(*s, dtype=torch.bfloat16) * 0.05)(D, D)),
        "w_v": _w((lambda *s: torch.randn(*s, dtype=torch.bfloat16) * 0.05)(D, D)),
    }

def reference(x, e_attr, src, dst, w_a, w_b, w_c, w_u, w_v):
    N, D = x.shape
    hv = x @ w_v
    g = x[dst] @ w_a + x[src] @ w_b + e_attr @ w_c
    eta = _sigmoid(g)
    denom = _segment_sum(eta, dst, N) + 1e-6
    eta_n = eta / denom[dst]
    agg = _segment_sum(eta_n * hv[src], dst, N)
    z = x @ w_u + agg
    relu_z = torch.where(z > 0, z, 0 * z)
    return x + relu_z
```

```asm
; @launch kernel=gcn_part_kernel grid=(265,1,1) block=(256,1,1) lds=27392
; @launch kernel=standalone__edge_featured_mpnn_gatedgcn__graph_kernel grid=(256,1,1) block=(512,1,1) lds=161024
.amdgcn_target "amdgcn-amd-amdhsa--gfx950"
.text
.globl gcn_part_kernel
.p2align 8
.type gcn_part_kernel,@function
gcn_part_kernel:
    s_load_dwordx2 s[4:5], s[0:1], 16
    s_load_dwordx2 s[6:7], s[0:1], 24
    s_load_dwordx2 s[8:9], s[0:1], 88
    s_cmp_ge_u32 s2, 256
    s_cbranch_scc1 A_frag
    s_waitcnt lgkmcnt(0)
    s_mov_b32 s12, s4
    s_mov_b32 s13, s5
    s_mov_b32 s14, 3200000
    s_mov_b32 s15, 0x00020000
    s_mov_b32 s16, s6
    s_mov_b32 s17, s7
    s_mov_b32 s18, 3200000
    s_mov_b32 s19, 0x00020000
    s_mov_b32 s20, s8
    s_mov_b32 s21, s9
    s_mov_b32 s22, 268435456
    s_mov_b32 s23, 0x00020000
    s_mul_i32 s3, s2, 12500
    v_lshlrev_b32 v1, 2, v0
    v_lshrrev_b32 v2, 6, v0
    s_nop 0
    v_readfirstlane_b32 s26, v2
    s_add_u32 s33, s3, 0
    buffer_load_dword v10, v1, s[16:19], s33 offen
    s_add_u32 s33, s3, 1024
    buffer_load_dword v11, v1, s[16:19], s33 offen
    s_add_u32 s33, s3, 2048
    buffer_load_dword v12, v1, s[16:19], s33 offen
    s_add_u32 s33, s3, 3072
    buffer_load_dword v13, v1, s[16:19], s33 offen
    s_add_u32 s33, s3, 4096
    buffer_load_dword v14, v1, s[16:19], s33 offen
    s_add_u32 s33, s3, 5120
    buffer_load_dword v15, v1, s[16:19], s33 offen
    s_add_u32 s33, s3, 6144
    buffer_load_dword v16, v1, s[16:19], s33 offen
    s_add_u32 s33, s3, 7168
    buffer_load_dword v17, v1, s[16:19], s33 offen
    s_add_u32 s33, s3, 8192
    buffer_load_dword v18, v1, s[16:19], s33 offen
    s_add_u32 s33, s3, 9216
    buffer_load_dword v19, v1, s[16:19], s33 offen
    s_add_u32 s33, s3, 10240
    buffer_load_dword v20, v1, s[16:19], s33 offen
    s_add_u32 s33, s3, 11264
    buffer_load_dword v21, v1, s[16:19], s33 offen
    s_add_u32 s33, s3, 12288
    buffer_load_dword v22, v1, s[16:19], s33 offen
    s_add_u32 s33, s3, 0
    buffer_load_dword v23, v1, s[12:15], s33 offen
    s_add_u32 s33, s3, 1024
    buffer_load_dword v24, v1, s[12:15], s33 offen
    s_add_u32 s33, s3, 2048
    buffer_load_dword v25, v1, s[12:15], s33 offen
    s_add_u32 s33, s3, 3072
    buffer_load_dword v26, v1, s[12:15], s33 offen
    s_add_u32 s33, s3, 4096
    buffer_load_dword v27, v1, s[12:15], s33 offen
    s_add_u32 s33, s3, 5120
    buffer_load_dword v28, v1, s[12:15], s33 offen
    s_add_u32 s33, s3, 6144
    buffer_load_dword v29, v1, s[12:15], s33 offen
    s_add_u32 s33, s3, 7168
    buffer_load_dword v30, v1, s[12:15], s33 offen
    s_add_u32 s33, s3, 8192
    buffer_load_dword v31, v1, s[12:15], s33 offen
    s_add_u32 s33, s3, 9216
    buffer_load_dword v32, v1, s[12:15], s33 offen
    s_add_u32 s33, s3, 10240
    buffer_load_dword v33, v1, s[12:15], s33 offen
    s_add_u32 s33, s3, 11264
    buffer_load_dword v34, v1, s[12:15], s33 offen
    s_add_u32 s33, s3, 12288
    buffer_load_dword v35, v1, s[12:15], s33 offen
    v_mov_b32 v3, 0
    ds_write_b32 v1, v3 offset:0
    v_cmp_gt_u32 s[24:25], 53, v0
    v_mov_b32 v4, 1
    s_waitcnt lgkmcnt(0)
    s_barrier
    s_waitcnt vmcnt(25)
    v_mul_u32_u24 v36, 0x29cc, v10
    v_lshrrev_b32 v36, 20, v36
    v_lshlrev_b32 v36, 2, v36
    ds_add_rtn_u32 v49, v36, v4 offset:0
    s_waitcnt vmcnt(24)
    v_mul_u32_u24 v37, 0x29cc, v11
    v_lshrrev_b32 v37, 20, v37
    v_lshlrev_b32 v37, 2, v37
    ds_add_rtn_u32 v50, v37, v4 offset:0
    s_waitcnt vmcnt(23)
    v_mul_u32_u24 v38, 0x29cc, v12
    v_lshrrev_b32 v38, 20, v38
    v_lshlrev_b32 v38, 2, v38
    ds_add_rtn_u32 v51, v38, v4 offset:0
    s_waitcnt vmcnt(22)
    v_mul_u32_u24 v39, 0x29cc, v13
    v_lshrrev_b32 v39, 20, v39
    v_lshlrev_b32 v39, 2, v39
    ds_add_rtn_u32 v52, v39, v4 offset:0
    s_waitcnt vmcnt(21)
    v_mul_u32_u24 v40, 0x29cc, v14
    v_lshrrev_b32 v40, 20, v40
    v_lshlrev_b32 v40, 2, v40
    ds_add_rtn_u32 v53, v40, v4 offset:0
    s_waitcnt vmcnt(20)
    v_mul_u32_u24 v41, 0x29cc, v15
    v_lshrrev_b32 v41, 20, v41
    v_lshlrev_b32 v41, 2, v41
    ds_add_rtn_u32 v54, v41, v4 offset:0
    s_waitcnt vmcnt(19)
    v_mul_u32_u24 v42, 0x29cc, v16
    v_lshrrev_b32 v42, 20, v42
    v_lshlrev_b32 v42, 2, v42
    ds_add_rtn_u32 v55, v42, v4 offset:0
    s_waitcnt vmcnt(18)
    v_mul_u32_u24 v43, 0x29cc, v17
    v_lshrrev_b32 v43, 20, v43
    v_lshlrev_b32 v43, 2, v43
    ds_add_rtn_u32 v56, v43, v4 offset:0
    s_waitcnt vmcnt(17)
    v_mul_u32_u24 v44, 0x29cc, v18
    v_lshrrev_b32 v44, 20, v44
    v_lshlrev_b32 v44, 2, v44
    ds_add_rtn_u32 v57, v44, v4 offset:0
    s_waitcnt vmcnt(16)
    v_mul_u32_u24 v45, 0x29cc, v19
    v_lshrrev_b32 v45, 20, v45
    v_lshlrev_b32 v45, 2, v45
    ds_add_rtn_u32 v58, v45, v4 offset:0
    s_waitcnt vmcnt(15)
    v_mul_u32_u24 v46, 0x29cc, v20
    v_lshrrev_b32 v46, 20, v46
    v_lshlrev_b32 v46, 2, v46
    ds_add_rtn_u32 v59, v46, v4 offset:0
    s_waitcnt vmcnt(14)
    v_mul_u32_u24 v47, 0x29cc, v21
    v_lshrrev_b32 v47, 20, v47
    v_lshlrev_b32 v47, 2, v47
    ds_add_rtn_u32 v60, v47, v4 offset:0
    s_waitcnt vmcnt(13)
    v_mul_u32_u24 v48, 0x29cc, v22
    v_lshrrev_b32 v48, 20, v48
    v_lshlrev_b32 v48, 2, v48
    s_mov_b64 exec, s[24:25]
    ds_add_rtn_u32 v61, v48, v4 offset:0
    s_mov_b64 exec, -1
    s_waitcnt lgkmcnt(0)
    s_barrier
    ds_read_b32 v5, v1 offset:0
    s_waitcnt lgkmcnt(0)
    v_mov_b32 v6, v5
    s_nop 1
    v_add_u32_dpp v6, v6, v6 row_shr:1 row_mask:0xf bank_mask:0xf bound_ctrl:0
    s_nop 1
    v_add_u32_dpp v6, v6, v6 row_shr:2 row_mask:0xf bank_mask:0xf bound_ctrl:0
    s_nop 1
    v_add_u32_dpp v6, v6, v6 row_shr:4 row_mask:0xf bank_mask:0xf bound_ctrl:0
    s_nop 1
    v_add_u32_dpp v6, v6, v6 row_shr:8 row_mask:0xf bank_mask:0xf bound_ctrl:0
    s_nop 1
    v_add_u32_dpp v6, v6, v6 row_bcast:15 row_mask:0xa bank_mask:0xf
    s_nop 1
    v_add_u32_dpp v6, v6, v6 row_bcast:31 row_mask:0xc bank_mask:0xf
    s_nop 1
    s_nop 0
    v_readlane_b32 s27, v6, 63
    v_mov_b32 v64, s26
    v_lshlrev_b32 v64, 2, v64
    v_mov_b32 v65, s27
    ds_write_b32 v64, v65 offset:2048
    s_waitcnt lgkmcnt(0)
    s_barrier
    v_mov_b32 v64, 0
    ds_read_b128 v[64:67], v64 offset:2048
    s_waitcnt lgkmcnt(0)
    s_nop 0
    v_readfirstlane_b32 s28, v64
    s_nop 0
    v_readfirstlane_b32 s29, v65
    s_nop 0
    v_readfirstlane_b32 s30, v66
    s_mov_b32 s27, 0
    s_cmp_gt_u32 s26, 0
    s_cselect_b32 s31, s28, 0
    s_add_u32 s27, s27, s31
    s_cmp_gt_u32 s26, 1
    s_cselect_b32 s31, s29, 0
    s_add_u32 s27, s27, s31
    s_cmp_gt_u32 s26, 2
    s_cselect_b32 s31, s30, 0
    s_add_u32 s27, s27, s31
    v_sub_u32 v6, v6, v5
    v_add_u32 v6, s27, v6
    ds_write_b32 v1, v6 offset:1024
    v_lshlrev_b32 v7, 10, v0
    s_lshl_b32 s27, s2, 2
    s_add_u32 s27, s27, 6400000
    buffer_store_dword v6, v7, s[20:23], s27 offen
    v_mov_b32 v8, 3125
    v_mov_b32 v9, 262144
    v_cmp_eq_u32 vcc, 0, v0
    s_and_saveexec_b64 s[28:29], vcc
    buffer_store_dword v8, v9, s[20:23], s27 offen
    s_mov_b64 exec, -1
    s_waitcnt lgkmcnt(0)
    s_barrier
    s_waitcnt vmcnt(0)
    ds_read_b32 v64, v36 offset:1024
    ds_read_b32 v65, v37 offset:1024
    ds_read_b32 v66, v38 offset:1024
    ds_read_b32 v67, v39 offset:1024
    ds_read_b32 v68, v40 offset:1024
    ds_read_b32 v69, v41 offset:1024
    ds_read_b32 v70, v42 offset:1024
    ds_read_b32 v71, v43 offset:1024
    ds_read_b32 v72, v44 offset:1024
    ds_read_b32 v73, v45 offset:1024
    ds_read_b32 v74, v46 offset:1024
    ds_read_b32 v75, v47 offset:1024
    ds_read_b32 v76, v48 offset:1024
    s_mul_i32 s30, s2, 3125
    s_waitcnt lgkmcnt(12)
    v_add_u32 v64, v64, v49
    v_lshlrev_b32 v64, 3, v64
    v_mul_u32_u24 v2, 49, v36
    v_lshrrev_b32 v2, 1, v2
    v_sub_u32 v2, v10, v2
    v_lshlrev_b32 v2, 24, v2
    v_add_u32 v3, 0, v0
    v_add_u32 v3, s30, v3
    v_or_b32 v10, v2, v3
    v_mov_b32 v2, v10
    v_mov_b32 v3, v23
    ds_write_b64 v64, v[2:3] offset:2304
    s_waitcnt lgkmcnt(11)
    v_add_u32 v65, v65, v50
    v_lshlrev_b32 v65, 3, v65
    v_mul_u32_u24 v2, 49, v37
    v_lshrrev_b32 v2, 1, v2
    v_sub_u32 v2, v11, v2
    v_lshlrev_b32 v2, 24, v2
    v_add_u32 v3, 256, v0
    v_add_u32 v3, s30, v3
    v_or_b32 v11, v2, v3
    v_mov_b32 v2, v11
    v_mov_b32 v3, v24
    ds_write_b64 v65, v[2:3] offset:2304
    s_waitcnt lgkmcnt(10)
    v_add_u32 v66, v66, v51
    v_lshlrev_b32 v66, 3, v66
    v_mul_u32_u24 v2, 49, v38
    v_lshrrev_b32 v2, 1, v2
    v_sub_u32 v2, v12, v2
    v_lshlrev_b32 v2, 24, v2
    v_add_u32 v3, 512, v0
    v_add_u32 v3, s30, v3
    v_or_b32 v12, v2, v3
    v_mov_b32 v2, v12
    v_mov_b32 v3, v25
    ds_write_b64 v66, v[2:3] offset:2304
    s_waitcnt lgkmcnt(9)
    v_add_u32 v67, v67, v52
    v_lshlrev_b32 v67, 3, v67
    v_mul_u32_u24 v2, 49, v39
    v_lshrrev_b32 v2, 1, v2
    v_sub_u32 v2, v13, v2
    v_lshlrev_b32 v2, 24, v2
    v_add_u32 v3, 768, v0
    v_add_u32 v3, s30, v3
    v_or_b32 v13, v2, v3
    v_mov_b32 v2, v13
    v_mov_b32 v3, v26
    ds_write_b64 v67, v[2:3] offset:2304
    s_waitcnt lgkmcnt(8)
    v_add_u32 v68, v68, v53
    v_lshlrev_b32 v68, 3, v68
    v_mul_u32_u24 v2, 49, v40
    v_lshrrev_b32 v2, 1, v2
    v_sub_u32 v2, v14, v2
    v_lshlrev_b32 v2, 24, v2
    v_add_u32 v3, 1024, v0
    v_add_u32 v3, s30, v3
    v_or_b32 v14, v2, v3
    v_mov_b32 v2, v14
    v_mov_b32 v3, v27
    ds_write_b64 v68, v[2:3] offset:2304
    s_waitcnt lgkmcnt(7)
    v_add_u32 v69, v69, v54
    v_lshlrev_b32 v69, 3, v69
    v_mul_u32_u24 v2, 49, v41
    v_lshrrev_b32 v2, 1, v2
    v_sub_u32 v2, v15, v2
    v_lshlrev_b32 v2, 24, v2
    v_add_u32 v3, 1280, v0
    v_add_u32 v3, s30, v3
    v_or_b32 v15, v2, v3
    v_mov_b32 v2, v15
    v_mov_b32 v3, v28
    ds_write_b64 v69, v[2:3] offset:2304
    s_waitcnt lgkmcnt(6)
    v_add_u32 v70, v70, v55
    v_lshlrev_b32 v70, 3, v70
    v_mul_u32_u24 v2, 49, v42
    v_lshrrev_b32 v2, 1, v2
    v_sub_u32 v2, v16, v2
    v_lshlrev_b32 v2, 24, v2
    v_add_u32 v3, 1536, v0
    v_add_u32 v3, s30, v3
    v_or_b32 v16, v2, v3
    v_mov_b32 v2, v16
    v_mov_b32 v3, v29
    ds_write_b64 v70, v[2:3] offset:2304
    s_waitcnt lgkmcnt(5)
    v_add_u32 v71, v71, v56
    v_lshlrev_b32 v71, 3, v71
    v_mul_u32_u24 v2, 49, v43
    v_lshrrev_b32 v2, 1, v2
    v_sub_u32 v2, v17, v2
    v_lshlrev_b32 v2, 24, v2
    v_add_u32 v3, 1792, v0
    v_add_u32 v3, s30, v3
    v_or_b32 v17, v2, v3
    v_mov_b32 v2, v17
    v_mov_b32 v3, v30
    ds_write_b64 v71, v[2:3] offset:2304
    s_waitcnt lgkmcnt(4)
    v_add_u32 v72, v72, v57
    v_lshlrev_b32 v72, 3, v72
    v_mul_u32_u24 v2, 49, v44
    v_lshrrev_b32 v2, 1, v2
    v_sub_u32 v2, v18, v2
    v_lshlrev_b32 v2, 24, v2
    v_add_u32 v3, 2048, v0
    v_add_u32 v3, s30, v3
    v_or_b32 v18, v2, v3
    v_mov_b32 v2, v18
    v_mov_b32 v3, v31
    ds_write_b64 v72, v[2:3] offset:2304
    s_waitcnt lgkmcnt(3)
    v_add_u32 v73, v73, v58
    v_lshlrev_b32 v73, 3, v73
    v_mul_u32_u24 v2, 49, v45
    v_lshrrev_b32 v2, 1, v2
    v_sub_u32 v2, v19, v2
    v_lshlrev_b32 v2, 24, v2
    v_add_u32 v3, 2304, v0
    v_add_u32 v3, s30, v3
    v_or_b32 v19, v2, v3
    v_mov_b32 v2, v19
    v_mov_b32 v3, v32
    ds_write_b64 v73, v[2:3] offset:2304
    s_waitcnt lgkmcnt(2)
    v_add_u32 v74, v74, v59
    v_lshlrev_b32 v74, 3, v74
    v_mul_u32_u24 v2, 49, v46
    v_lshrrev_b32 v2, 1, v2
    v_sub_u32 v2, v20, v2
    v_lshlrev_b32 v2, 24, v2
    v_add_u32 v3, 2560, v0
    v_add_u32 v3, s30, v3
    v_or_b32 v20, v2, v3
    v_mov_b32 v2, v20
    v_mov_b32 v3, v33
    ds_write_b64 v74, v[2:3] offset:2304
    s_waitcnt lgkmcnt(1)
    v_add_u32 v75, v75, v60
    v_lshlrev_b32 v75, 3, v75
    v_mul_u32_u24 v2, 49, v47
    v_lshrrev_b32 v2, 1, v2
    v_sub_u32 v2, v21, v2
    v_lshlrev_b32 v2, 24, v2
    v_add_u32 v3, 2816, v0
    v_add_u32 v3, s30, v3
    v_or_b32 v21, v2, v3
    v_mov_b32 v2, v21
    v_mov_b32 v3, v34
    ds_write_b64 v75, v[2:3] offset:2304
    s_waitcnt lgkmcnt(0)
    v_add_u32 v76, v76, v61
    v_lshlrev_b32 v76, 3, v76
    v_mul_u32_u24 v2, 49, v48
    v_lshrrev_b32 v2, 1, v2
    v_sub_u32 v2, v22, v2
    v_lshlrev_b32 v2, 24, v2
    v_add_u32 v3, 3072, v0
    v_add_u32 v3, s30, v3
    v_or_b32 v22, v2, v3
    s_mov_b64 exec, s[24:25]
    v_mov_b32 v2, v22
    v_mov_b32 v3, v35
    ds_write_b64 v76, v[2:3] offset:2304
    s_mov_b64 exec, -1
    s_waitcnt lgkmcnt(0)
    s_barrier
    v_lshlrev_b32 v1, 3, v0
    ds_read_b64 v[64:65], v1 offset:2304
    ds_read_b64 v[66:67], v1 offset:4352
    ds_read_b64 v[68:69], v1 offset:6400
    ds_read_b64 v[70:71], v1 offset:8448
    ds_read_b64 v[72:73], v1 offset:10496
    ds_read_b64 v[74:75], v1 offset:12544
    ds_read_b64 v[76:77], v1 offset:14592
    ds_read_b64 v[78:79], v1 offset:16640
    ds_read_b64 v[80:81], v1 offset:18688
    ds_read_b64 v[82:83], v1 offset:20736
    ds_read_b64 v[84:85], v1 offset:22784
    ds_read_b64 v[86:87], v1 offset:24832
    ds_read_b64 v[88:89], v1 offset:26880
    s_mul_i32 s31, s2, 25000
    s_waitcnt lgkmcnt(12)
    s_add_u32 s32, s31, 0
    buffer_store_dwordx2 v[64:65], v1, s[20:23], s32 offen
    s_waitcnt lgkmcnt(11)
    s_add_u32 s32, s31, 2048
    buffer_store_dwordx2 v[66:67], v1, s[20:23], s32 offen
    s_waitcnt lgkmcnt(10)
    s_add_u32 s32, s31, 4096
    buffer_store_dwordx2 v[68:69], v1, s[20:23], s32 offen
    s_waitcnt lgkmcnt(9)
    s_add_u32 s32, s31, 6144
    buffer_store_dwordx2 v[70:71], v1, s[20:23], s32 offen
    s_waitcnt lgkmcnt(8)
    s_add_u32 s32, s31, 8192
    buffer_store_dwordx2 v[72:73], v1, s[20:23], s32 offen
    s_waitcnt lgkmcnt(7)
    s_add_u32 s32, s31, 10240
    buffer_store_dwordx2 v[74:75], v1, s[20:23], s32 offen
    s_waitcnt lgkmcnt(6)
    s_add_u32 s32, s31, 12288
    buffer_store_dwordx2 v[76:77], v1, s[20:23], s32 offen
    s_waitcnt lgkmcnt(5)
    s_add_u32 s32, s31, 14336
    buffer_store_dwordx2 v[78:79], v1, s[20:23], s32 offen
    s_waitcnt lgkmcnt(4)
    s_add_u32 s32, s31, 16384
    buffer_store_dwordx2 v[80:81], v1, s[20:23], s32 offen
    s_waitcnt lgkmcnt(3)
    s_add_u32 s32, s31, 18432
    buffer_store_dwordx2 v[82:83], v1, s[20:23], s32 offen
    s_waitcnt lgkmcnt(2)
    s_add_u32 s32, s31, 20480
    buffer_store_dwordx2 v[84:85], v1, s[20:23], s32 offen
    s_waitcnt lgkmcnt(1)
    s_add_u32 s32, s31, 22528
    buffer_store_dwordx2 v[86:87], v1, s[20:23], s32 offen
    s_waitcnt lgkmcnt(0)
    s_mov_b64 exec, s[24:25]
    s_add_u32 s32, s31, 24576
    buffer_store_dwordx2 v[88:89], v1, s[20:23], s32 offen
    s_endpgm
A_frag:
    s_sub_u32 s3, s2, 256
    v_lshrrev_b32 v2, 6, v0
    s_nop 0
    v_readfirstlane_b32 s26, v2
    s_lshl_b32 s3, s3, 2
    s_add_u32 s3, s3, s26
    s_cmp_ge_u32 s3, 36
    s_cbranch_scc1 A_end
    s_load_dwordx2 s[34:35], s[0:1], 32
    s_load_dwordx2 s[36:37], s[0:1], 40
    s_load_dwordx2 s[38:39], s[0:1], 48
    s_load_dwordx2 s[40:41], s[0:1], 56
    s_load_dwordx2 s[42:43], s[0:1], 64
    s_waitcnt lgkmcnt(0)
    s_mov_b32 s20, s8
    s_mov_b32 s21, s9
    s_mov_b32 s22, 268435456
    s_mov_b32 s23, 0x00020000
    s_mov_b64 s[44:45], s[36:37]
    s_mov_b32 s27, s3
    s_cmp_ge_u32 s3, 8
    s_cselect_b64 s[44:45], s[42:43], s[44:45]
    s_cselect_b32 s28, 8, 0
    s_sub_u32 s27, s3, s28
    s_cmp_ge_u32 s3, 16
    s_cselect_b64 s[44:45], s[38:39], s[44:45]
    s_cselect_b32 s28, 16, s28
    s_sub_u32 s27, s3, s28
    s_cmp_ge_u32 s3, 20
    s_cselect_b64 s[44:45], s[34:35], s[44:45]
    s_cselect_b32 s28, 20, s28
    s_sub_u32 s27, s3, s28
    s_cmp_ge_u32 s3, 28
    s_cselect_b64 s[44:45], s[40:41], s[44:45]
    s_cselect_b32 s28, 28, s28
    s_sub_u32 s27, s3, s28
    s_mov_b32 s12, s44
    s_mov_b32 s13, s45
    s_mov_b32 s14, 8192
    s_mov_b32 s15, 0x00020000
    v_and_b32 v1, 63, v0
    v_and_b32 v2, 15, v1
    v_lshrrev_b32 v3, 4, v1
    s_lshl_b32 s29, s3, 10
    s_add_u32 s29, s29, 6663168
    v_lshlrev_b32 v4, 4, v1
    s_cmp_eq_u32 s28, 16
    s_cbranch_scc1 A_fragc
    s_lshr_b32 s30, s27, 1
    s_and_b32 s31, s27, 1
    s_lshl_b32 s30, s30, 5
    s_lshl_b32 s31, s31, 12
    s_add_u32 s30, s30, s31
    v_lshlrev_b32 v5, 10, v3
    v_lshl_add_u32 v5, v2, 1, v5
    buffer_load_ushort v8, v5, s[12:15], s30 offen offset:0
    buffer_load_ushort v9, v5, s[12:15], s30 offen offset:128
    buffer_load_ushort v10, v5, s[12:15], s30 offen offset:256
    buffer_load_ushort v11, v5, s[12:15], s30 offen offset:384
    buffer_load_ushort v12, v5, s[12:15], s30 offen offset:512
    buffer_load_ushort v13, v5, s[12:15], s30 offen offset:640
    buffer_load_ushort v14, v5, s[12:15], s30 offen offset:768
    buffer_load_ushort v15, v5, s[12:15], s30 offen offset:896
    s_waitcnt vmcnt(0)
    v_lshl_or_b32 v16, v9, 16, v8
    v_lshl_or_b32 v17, v11, 16, v10
    v_lshl_or_b32 v18, v13, 16, v12
    v_lshl_or_b32 v19, v15, 16, v14
    buffer_store_dwordx4 v[16:19], v4, s[20:23], s29 offen
    s_endpgm
A_fragc:
    s_lshl_b32 s30, s27, 5
    v_lshlrev_b32 v5, 9, v3
    v_lshl_add_u32 v5, v2, 1, v5
    buffer_load_ushort v8, v5, s[12:15], s30 offen offset:0
    buffer_load_ushort v9, v5, s[12:15], s30 offen offset:128
    buffer_load_ushort v10, v5, s[12:15], s30 offen offset:256
    buffer_load_ushort v11, v5, s[12:15], s30 offen offset:384
    s_waitcnt vmcnt(0)
    v_lshl_or_b32 v16, v9, 16, v8
    v_lshl_or_b32 v17, v11, 16, v10
    v_lshlrev_b32 v4, 3, v1
    buffer_store_dwordx2 v[16:17], v4, s[20:23], s29 offen
A_end:
    s_endpgm
.globl standalone__edge_featured_mpnn_gatedgcn__graph_kernel
.p2align 8
.type standalone__edge_featured_mpnn_gatedgcn__graph_kernel,@function
standalone__edge_featured_mpnn_gatedgcn__graph_kernel:
    s_load_dwordx2 s[4:5], s[0:1], 0
    s_load_dwordx2 s[6:7], s[0:1], 8
    s_load_dwordx2 s[8:9], s[0:1], 88
    s_load_dwordx2 s[10:11], s[0:1], 72
    s_cmp_ge_u32 s2, 256
    s_cbranch_scc1 C_end
    s_waitcnt lgkmcnt(0)
    s_mov_b32 s12, s4
    s_mov_b32 s13, s5
    s_mov_b32 s14, 3200000
    s_mov_b32 s15, 0x00020000
    s_mov_b32 s24, s6
    s_mov_b32 s25, s7
    s_mov_b32 s26, 25600000
    s_mov_b32 s27, 0x00020000
    s_mov_b32 s16, s8
    s_mov_b32 s17, s9
    s_mov_b32 s18, 268435456
    s_mov_b32 s19, 0x00020000
    s_mov_b32 s20, s10
    s_mov_b32 s21, s11
    s_mov_b32 s22, 3200000
    s_mov_b32 s23, 0x00020000
    s_mul_i32 s3, s2, 98
    v_and_b32 v3, 63, v0
    v_and_b32 v1, 15, v0
    v_bfe_u32 v2, v0, 4, 2
    v_lshrrev_b32 v5, 6, v0
    s_nop 0
    v_readfirstlane_b32 s38, v5
    v_lshlrev_b32 v4, 4, v3
    s_mov_b32 s39, 6663168
    s_cmp_ge_u32 s38, 7
    s_cbranch_scc1 C_p0b
    s_add_u32 s40, s39, 20480
    buffer_load_dwordx4 v[64:67], v4, s[16:19], s40 offen
    s_add_u32 s40, s39, 21504
    buffer_load_dwordx4 v[68:71], v4, s[16:19], s40 offen
    s_add_u32 s40, s39, 22528
    buffer_load_dwordx4 v[72:75], v4, s[16:19], s40 offen
    s_add_u32 s40, s39, 23552
    buffer_load_dwordx4 v[76:79], v4, s[16:19], s40 offen
    s_add_u32 s40, s39, 24576
    buffer_load_dwordx4 v[80:83], v4, s[16:19], s40 offen
    s_add_u32 s40, s39, 25600
    buffer_load_dwordx4 v[84:87], v4, s[16:19], s40 offen
    s_add_u32 s40, s39, 26624
    buffer_load_dwordx4 v[88:91], v4, s[16:19], s40 offen
    s_add_u32 s40, s39, 27648
    buffer_load_dwordx4 v[92:95], v4, s[16:19], s40 offen
    s_add_u32 s40, s39, 28672
    buffer_load_dwordx4 v[96:99], v4, s[16:19], s40 offen
    s_add_u32 s40, s39, 29696
    buffer_load_dwordx4 v[100:103], v4, s[16:19], s40 offen
    s_add_u32 s40, s39, 30720
    buffer_load_dwordx4 v[104:107], v4, s[16:19], s40 offen
    s_add_u32 s40, s39, 31744
    buffer_load_dwordx4 v[108:111], v4, s[16:19], s40 offen
    s_add_u32 s40, s39, 32768
    buffer_load_dwordx4 v[112:115], v4, s[16:19], s40 offen
    s_add_u32 s40, s39, 33792
    buffer_load_dwordx4 v[116:119], v4, s[16:19], s40 offen
    s_add_u32 s40, s39, 34816
    buffer_load_dwordx4 v[120:123], v4, s[16:19], s40 offen
    s_add_u32 s40, s39, 35840
    buffer_load_dwordx4 v[124:127], v4, s[16:19], s40 offen
    s_lshl_b32 s41, s38, 4
    s_add_u32 s41, s41, s3
    v_add_u32 v6, s41, v1
    v_lshlrev_b32 v6, 7, v6
    v_lshl_add_u32 v6, v2, 4, v6
    buffer_load_dwordx4 v[8:11], v6, s[12:15], 0 offen
    buffer_load_dwordx4 v[12:15], v6, s[12:15], 0 offen offset:64
    s_waitcnt vmcnt(0)
    v_mfma_f32_16x16x32_bf16 v[16:19], v[8:11], v[64:67], 0
    v_mfma_f32_16x16x32_bf16 v[20:23], v[8:11], v[72:75], 0
    v_mfma_f32_16x16x32_bf16 v[24:27], v[8:11], v[80:83], 0
    v_mfma_f32_16x16x32_bf16 v[28:31], v[8:11], v[88:91], 0
    v_mfma_f32_16x16x32_bf16 v[32:35], v[8:11], v[96:99], 0
    v_mfma_f32_16x16x32_bf16 v[36:39], v[8:11], v[104:107], 0
    v_mfma_f32_16x16x32_bf16 v[40:43], v[8:11], v[112:115], 0
    v_mfma_f32_16x16x32_bf16 v[44:47], v[8:11], v[120:123], 0
    v_mfma_f32_16x16x32_bf16 v[16:19], v[12:15], v[68:71], v[16:19]
    v_mfma_f32_16x16x32_bf16 v[20:23], v[12:15], v[76:79], v[20:23]
    v_mfma_f32_16x16x32_bf16 v[24:27], v[12:15], v[84:87], v[24:27]
    v_mfma_f32_16x16x32_bf16 v[28:31], v[12:15], v[92:95], v[28:31]
    v_mfma_f32_16x16x32_bf16 v[32:35], v[12:15], v[100:103], v[32:35]
    v_mfma_f32_16x16x32_bf16 v[36:39], v[12:15], v[108:111], v[36:39]
    v_mfma_f32_16x16x32_bf16 v[40:43], v[12:15], v[116:119], v[40:43]
    v_mfma_f32_16x16x32_bf16 v[44:47], v[12:15], v[124:127], v[44:47]
    s_nop 7
    s_nop 7
    v_lshlrev_b32 v6, 10, v2
    v_lshl_add_u32 v6, v1, 2, v6
    s_lshl_b32 s41, s38, 12
    v_add_u32 v6, s41, v6
    v_cvt_pk_bf16_f32 v7, v16, v17
    v_lshlrev_b32 v16, 16, v7
    v_and_b32 v17, 0xffff0000, v7
    v_add_u32 v63, 90112, v6
    ds_write_b32 v63, v16 offset:0
    v_add_u32 v63, 90112, v6
    ds_write_b32 v63, v17 offset:256
    v_cvt_pk_bf16_f32 v7, v18, v19
    v_lshlrev_b32 v18, 16, v7
    v_and_b32 v19, 0xffff0000, v7
    v_add_u32 v63, 90112, v6
    ds_write_b32 v63, v18 offset:512
    v_add_u32 v63, 90112, v6
    ds_write_b32 v63, v19 offset:768
    v_cvt_pk_bf16_f32 v7, v20, v21
    v_lshlrev_b32 v20, 16, v7
    v_and_b32 v21, 0xffff0000, v7
    v_add_u32 v63, 90112, v6
    ds_write_b32 v63, v20 offset:64
    v_add_u32 v63, 90112, v6
    ds_write_b32 v63, v21 offset:320
    v_cvt_pk_bf16_f32 v7, v22, v23
    v_lshlrev_b32 v22, 16, v7
    v_and_b32 v23, 0xffff0000, v7
    v_add_u32 v63, 90112, v6
    ds_write_b32 v63, v22 offset:576
    v_add_u32 v63, 90112, v6
    ds_write_b32 v63, v23 offset:832
    v_cvt_pk_bf16_f32 v7, v24, v25
    v_lshlrev_b32 v24, 16, v7
    v_and_b32 v25, 0xffff0000, v7
    v_add_u32 v63, 90112, v6
    ds_write_b32 v63, v24 offset:128
    v_add_u32 v63, 90112, v6
    ds_write_b32 v63, v25 offset:384
    v_cvt_pk_bf16_f32 v7, v26, v27
    v_lshlrev_b32 v26, 16, v7
    v_and_b32 v27, 0xffff0000, v7
    v_add_u32 v63, 90112, v6
    ds_write_b32 v63, v26 offset:640
    v_add_u32 v63, 90112, v6
    ds_write_b32 v63, v27 offset:896
    v_cvt_pk_bf16_f32 v7, v28, v29
    v_lshlrev_b32 v28, 16, v7
    v_and_b32 v29, 0xffff0000, v7
    v_add_u32 v63, 90112, v6
    ds_write_b32 v63, v28 offset:192
    v_add_u32 v63, 90112, v6
    ds_write_b32 v63, v29 offset:448
    v_cvt_pk_bf16_f32 v7, v30, v31
    v_lshlrev_b32 v30, 16, v7
    v_and_b32 v31, 0xffff0000, v7
    v_add_u32 v63, 90112, v6
    ds_write_b32 v63, v30 offset:704
    v_add_u32 v63, 90112, v6
    ds_write_b32 v63, v31 offset:960
    v_cvt_pk_bf16_f32 v7, v32, v33
    v_lshlrev_b32 v32, 16, v7
    v_and_b32 v33, 0xffff0000, v7
    v_add_u32 v63, 118784, v6
    ds_write_b32 v63, v32 offset:0
    v_add_u32 v63, 118784, v6
    ds_write_b32 v63, v33 offset:256
    v_cvt_pk_bf16_f32 v7, v34, v35
    v_lshlrev_b32 v34, 16, v7
    v_and_b32 v35, 0xffff0000, v7
    v_add_u32 v63, 118784, v6
    ds_write_b32 v63, v34 offset:512
    v_add_u32 v63, 118784, v6
    ds_write_b32 v63, v35 offset:768
    v_cvt_pk_bf16_f32 v7, v36, v37
    v_lshlrev_b32 v36, 16, v7
    v_and_b32 v37, 0xffff0000, v7
    v_add_u32 v63, 118784, v6
    ds_write_b32 v63, v36 offset:64
    v_add_u32 v63, 118784, v6
    ds_write_b32 v63, v37 offset:320
    v_cvt_pk_bf16_f32 v7, v38, v39
    v_lshlrev_b32 v38, 16, v7
    v_and_b32 v39, 0xffff0000, v7
    v_add_u32 v63, 118784, v6
    ds_write_b32 v63, v38 offset:576
    v_add_u32 v63, 118784, v6
    ds_write_b32 v63, v39 offset:832
    v_cvt_pk_bf16_f32 v7, v40, v41
    v_lshlrev_b32 v40, 16, v7
    v_and_b32 v41, 0xffff0000, v7
    v_add_u32 v63, 118784, v6
    ds_write_b32 v63, v40 offset:128
    v_add_u32 v63, 118784, v6
    ds_write_b32 v63, v41 offset:384
    v_cvt_pk_bf16_f32 v7, v42, v43
    v_lshlrev_b32 v42, 16, v7
    v_and_b32 v43, 0xffff0000, v7
    v_add_u32 v63, 118784, v6
    ds_write_b32 v63, v42 offset:640
    v_add_u32 v63, 118784, v6
    ds_write_b32 v63, v43 offset:896
    v_cvt_pk_bf16_f32 v7, v44, v45
    v_lshlrev_b32 v44, 16, v7
    v_and_b32 v45, 0xffff0000, v7
    v_add_u32 v63, 118784, v6
    ds_write_b32 v63, v44 offset:192
    v_add_u32 v63, 118784, v6
    ds_write_b32 v63, v45 offset:448
    v_cvt_pk_bf16_f32 v7, v46, v47
    v_lshlrev_b32 v46, 16, v7
    v_and_b32 v47, 0xffff0000, v7
    v_add_u32 v63, 118784, v6
    ds_write_b32 v63, v46 offset:704
    v_add_u32 v63, 118784, v6
    ds_write_b32 v63, v47 offset:960
C_p0b:
    s_add_u32 s40, s39, 0
    buffer_load_dwordx4 v[64:67], v4, s[16:19], s40 offen
    s_add_u32 s40, s39, 1024
    buffer_load_dwordx4 v[68:71], v4, s[16:19], s40 offen
    s_add_u32 s40, s39, 2048
    buffer_load_dwordx4 v[72:75], v4, s[16:19], s40 offen
    s_add_u32 s40, s39, 3072
    buffer_load_dwordx4 v[76:79], v4, s[16:19], s40 offen
    s_add_u32 s40, s39, 4096
    buffer_load_dwordx4 v[80:83], v4, s[16:19], s40 offen
    s_add_u32 s40, s39, 5120
    buffer_load_dwordx4 v[84:87], v4, s[16:19], s40 offen
    s_add_u32 s40, s39, 6144
    buffer_load_dwordx4 v[88:91], v4, s[16:19], s40 offen
    s_add_u32 s40, s39, 7168
    buffer_load_dwordx4 v[92:95], v4, s[16:19], s40 offen
    s_add_u32 s40, s39, 8192
    buffer_load_dwordx4 v[96:99], v4, s[16:19], s40 offen
    s_add_u32 s40, s39, 9216
    buffer_load_dwordx4 v[100:103], v4, s[16:19], s40 offen
    s_add_u32 s40, s39, 10240
    buffer_load_dwordx4 v[104:107], v4, s[16:19], s40 offen
    s_add_u32 s40, s39, 11264
    buffer_load_dwordx4 v[108:111], v4, s[16:19], s40 offen
    s_add_u32 s40, s39, 12288
    buffer_load_dwordx4 v[112:115], v4, s[16:19], s40 offen
    s_add_u32 s40, s39, 13312
    buffer_load_dwordx4 v[116:119], v4, s[16:19], s40 offen
    s_add_u32 s40, s39, 14336
    buffer_load_dwordx4 v[120:123], v4, s[16:19], s40 offen
    s_add_u32 s40, s39, 15360
    buffer_load_dwordx4 v[124:127], v4, s[16:19], s40 offen
    v_lshlrev_b32 v5, 3, v3
    s_add_u32 s40, s39, 16384
    buffer_load_dwordx2 v[128:129], v5, s[16:19], s40 offen
    s_add_u32 s40, s39, 17408
    buffer_load_dwordx2 v[130:131], v5, s[16:19], s40 offen
    s_add_u32 s40, s39, 18432
    buffer_load_dwordx2 v[132:133], v5, s[16:19], s40 offen
    s_add_u32 s40, s39, 19456
    buffer_load_dwordx2 v[134:135], v5, s[16:19], s40 offen
    v_mov_b32 v8, 0
    v_mov_b32 v9, 0
    v_mov_b32 v10, 0
    v_mov_b32 v11, 0
    v_lshlrev_b32 v6, 4, v0
    ds_write_b128 v6, v[8:11] offset:32768
    ds_write_b128 v6, v[8:11] offset:40960
    ds_write_b128 v6, v[8:11] offset:49152
    ds_write_b128 v6, v[8:11] offset:57344
    v_add_u32 v63, 65536, v6
    ds_write_b128 v63, v[8:11] offset:0
    v_add_u32 v63, 73728, v6
    ds_write_b128 v63, v[8:11] offset:0
    v_add_u32 v63, 81920, v6
    ds_write_b128 v63, v[8:11] offset:0
    v_lshlrev_b32 v6, 2, v0
    s_lshl_b32 s41, s2, 10
    s_add_u32 s41, s41, 6400000
    s_cmp_ge_u32 s38, 4
    s_cbranch_scc1 C_p0c
    buffer_load_dword v20, v6, s[16:19], s41 offen
    buffer_load_dword v21, v6, s[16:19], s41 offen offset:1024
    s_waitcnt vmcnt(0)
    v_sub_u32 v21, v21, v20
C_p0c:
    s_cmp_ge_u32 s38, 4
    s_cbranch_scc0 C_p0d
    v_mov_b32 v20, 0
    v_mov_b32 v21, 0
C_p0d:
    v_mov_b32 v22, v21
    s_nop 1
    v_add_u32_dpp v22, v22, v22 row_shr:1 row_mask:0xf bank_mask:0xf bound_ctrl:0
    s_nop 1
    v_add_u32_dpp v22, v22, v22 row_shr:2 row_mask:0xf bank_mask:0xf bound_ctrl:0
    s_nop 1
    v_add_u32_dpp v22, v22, v22 row_shr:4 row_mask:0xf bank_mask:0xf bound_ctrl:0
    s_nop 1
    v_add_u32_dpp v22, v22, v22 row_shr:8 row_mask:0xf bank_mask:0xf bound_ctrl:0
    s_nop 1
    v_add_u32_dpp v22, v22, v22 row_bcast:15 row_mask:0xa bank_mask:0xf
    s_nop 1
    v_add_u32_dpp v22, v22, v22 row_bcast:31 row_mask:0xc bank_mask:0xf
    s_nop 1
    s_nop 0
    v_readlane_b32 s42, v22, 63
    v_mov_b32 v24, s38
    v_lshlrev_b32 v24, 2, v24
    v_mov_b32 v25, s42
    v_add_u32 v63, 147456, v24
    ds_write_b32 v63, v25 offset:1024
    s_waitcnt lgkmcnt(0)
    s_barrier
    v_mov_b32 v24, 0
    v_add_u32 v63, 147456, v24
    ds_read_b128 v[24:27], v63 offset:1024
    s_waitcnt lgkmcnt(0)
    s_nop 0
    v_readfirstlane_b32 s43, v24
    s_nop 0
    v_readfirstlane_b32 s44, v25
    s_nop 0
    v_readfirstlane_b32 s45, v26
    s_mov_b32 s42, 0
    s_cmp_gt_u32 s38, 0
    s_cselect_b32 s46, s43, 0
    s_add_u32 s42, s42, s46
    s_cmp_gt_u32 s38, 1
    s_cselect_b32 s46, s44, 0
    s_add_u32 s42, s42, s46
    s_cmp_gt_u32 s38, 2
    s_cselect_b32 s46, s45, 0
    s_add_u32 s42, s42, s46
    v_sub_u32 v22, v22, v21
    v_add_u32 v22, s42, v22
    v_mov_b32 v24, 0
    v_add_u32 v63, 147456, v24
    ds_read_b128 v[24:27], v63 offset:1024
    s_waitcnt lgkmcnt(0)
    v_add_u32 v24, v24, v25
    v_add_u32 v26, v26, v27
    v_add_u32 v24, v24, v26
    s_nop 0
    v_readfirstlane_b32 s47, v24
    v_mul_u32_u24 v23, 25000, v0
    v_lshl_add_u32 v23, v20, 3, v23
    s_mov_b32 s48, 0
C_round:
    s_cmp_ge_u32 s38, 4
    s_cbranch_scc1 C_cp_done
    v_mov_b32 v28, 0
C_cp_loop:
    v_cmp_lt_u32 vcc, v28, v21
    s_cbranch_vccz C_cp_done
    v_add_u32 v30, 0, v28
    v_cmp_lt_u32 s[50:51], v30, v21
    v_add_u32 v30, v30, v22
    v_subrev_u32 v30, s48, v30
    v_cmp_gt_u32 vcc, 4096, v30
    s_and_b64 s[50:51], s[50:51], vcc
    v_lshlrev_b32 v30, 3, v30
    v_lshl_add_u32 v29, v28, 3, v23
    s_mov_b64 exec, s[50:51]
    buffer_load_dwordx2 v[36:37], v29, s[16:19], 0 offen offset:0
    s_mov_b64 exec, -1
    v_add_u32 v31, 1, v28
    v_cmp_lt_u32 s[52:53], v31, v21
    v_add_u32 v31, v31, v22
    v_subrev_u32 v31, s48, v31
    v_cmp_gt_u32 vcc, 4096, v31
    s_and_b64 s[52:53], s[52:53], vcc
    v_lshlrev_b32 v31, 3, v31
    v_lshl_add_u32 v29, v28, 3, v23
    s_mov_b64 exec, s[52:53]
    buffer_load_dwordx2 v[38:39], v29, s[16:19], 0 offen offset:8
    s_mov_b64 exec, -1
    v_add_u32 v32, 2, v28
    v_cmp_lt_u32 s[54:55], v32, v21
    v_add_u32 v32, v32, v22
    v_subrev_u32 v32, s48, v32
    v_cmp_gt_u32 vcc, 4096, v32
    s_and_b64 s[54:55], s[54:55], vcc
    v_lshlrev_b32 v32, 3, v32
    v_lshl_add_u32 v29, v28, 3, v23
    s_mov_b64 exec, s[54:55]
    buffer_load_dwordx2 v[40:41], v29, s[16:19], 0 offen offset:16
    s_mov_b64 exec, -1
    v_add_u32 v33, 3, v28
    v_cmp_lt_u32 s[56:57], v33, v21
    v_add_u32 v33, v33, v22
    v_subrev_u32 v33, s48, v33
    v_cmp_gt_u32 vcc, 4096, v33
    s_and_b64 s[56:57], s[56:57], vcc
    v_lshlrev_b32 v33, 3, v33
    v_lshl_add_u32 v29, v28, 3, v23
    s_mov_b64 exec, s[56:57]
    buffer_load_dwordx2 v[42:43], v29, s[16:19], 0 offen offset:24
    s_mov_b64 exec, -1
    s_waitcnt vmcnt(3)
    s_mov_b64 exec, s[50:51]
    ds_write_b64 v30, v[36:37] offset:0
    s_mov_b64 exec, -1
    s_waitcnt vmcnt(2)
    s_mov_b64 exec, s[52:53]
    ds_write_b64 v31, v[38:39] offset:0
    s_mov_b64 exec, -1
    s_waitcnt vmcnt(1)
    s_mov_b64 exec, s[54:55]
    ds_write_b64 v32, v[40:41] offset:0
    s_mov_b64 exec, -1
    s_waitcnt vmcnt(0)
    s_mov_b64 exec, s[56:57]
    ds_write_b64 v33, v[42:43] offset:0
    s_mov_b64 exec, -1
    v_add_u32 v28, 4, v28
    s_branch C_cp_loop
C_cp_done:
    v_lshlrev_b32 v6, 2, v0
    v_mov_b32 v7, 0
    v_cmp_gt_u32 vcc, 128, v0
    s_and_saveexec_b64 s[50:51], vcc
    v_add_u32 v63, 147456, v6
    ds_write_b32 v63, v7 offset:0
    s_mov_b64 exec, -1
    s_waitcnt vmcnt(0) lgkmcnt(0)
    s_barrier
    s_sub_u32 s49, s47, s48
    s_min_u32 s49, s49, 4096
    v_lshlrev_b32 v6, 3, v0
    v_mov_b32 v7, 1
    v_add_u32 v5, 0, v0
    v_cmp_gt_u32 s[50:51], s49, v5
    s_mov_b64 exec, s[50:51]
    ds_read_b64 v[28:29], v6 offset:0
    s_mov_b64 exec, -1
    v_add_u32 v5, 512, v0
    v_cmp_gt_u32 s[52:53], s49, v5
    s_mov_b64 exec, s[52:53]
    ds_read_b64 v[30:31], v6 offset:4096
    s_mov_b64 exec, -1
    v_add_u32 v5, 1024, v0
    v_cmp_gt_u32 s[54:55], s49, v5
    s_mov_b64 exec, s[54:55]
    ds_read_b64 v[32:33], v6 offset:8192
    s_mov_b64 exec, -1
    v_add_u32 v5, 1536, v0
    v_cmp_gt_u32 s[56:57], s49, v5
    s_mov_b64 exec, s[56:57]
    ds_read_b64 v[34:35], v6 offset:12288
    s_mov_b64 exec, -1
    v_add_u32 v5, 2048, v0
    v_cmp_gt_u32 s[58:59], s49, v5
    s_mov_b64 exec, s[58:59]
    ds_read_b64 v[36:37], v6 offset:16384
    s_mov_b64 exec, -1
    v_add_u32 v5, 2560, v0
    v_cmp_gt_u32 s[60:61], s49, v5
    s_mov_b64 exec, s[60:61]
    ds_read_b64 v[38:39], v6 offset:20480
    s_mov_b64 exec, -1
    v_add_u32 v5, 3072, v0
    v_cmp_gt_u32 s[62:63], s49, v5
    s_mov_b64 exec, s[62:63]
    ds_read_b64 v[40:41], v6 offset:24576
    s_mov_b64 exec, -1
    v_add_u32 v5, 3584, v0
    v_cmp_gt_u32 s[64:65], s49, v5
    s_mov_b64 exec, s[64:65]
    ds_read_b64 v[42:43], v6 offset:28672
    s_mov_b64 exec, -1
    s_waitcnt lgkmcnt(0)
    v_lshrrev_b32 v5, 24, v28
    v_lshlrev_b32 v5, 2, v5
    s_mov_b64 exec, s[50:51]
    v_add_u32 v63, 147456, v5
    ds_add_rtn_u32 v44, v63, v7 offset:0
    s_mov_b64 exec, -1
    v_lshrrev_b32 v5, 24, v30
    v_lshlrev_b32 v5, 2, v5
    s_mov_b64 exec, s[52:53]
    v_add_u32 v63, 147456, v5
    ds_add_rtn_u32 v45, v63, v7 offset:0
    s_mov_b64 exec, -1
    v_lshrrev_b32 v5, 24, v32
    v_lshlrev_b32 v5, 2, v5
    s_mov_b64 exec, s[54:55]
    v_add_u32 v63, 147456, v5
    ds_add_rtn_u32 v46, v63, v7 offset:0
    s_mov_b64 exec, -1
    v_lshrrev_b32 v5, 24, v34
    v_lshlrev_b32 v5, 2, v5
    s_mov_b64 exec, s[56:57]
    v_add_u32 v63, 147456, v5
    ds_add_rtn_u32 v47, v63, v7 offset:0
    s_mov_b64 exec, -1
    v_lshrrev_b32 v5, 24, v36
    v_lshlrev_b32 v5, 2, v5
    s_mov_b64 exec, s[58:59]
    v_add_u32 v63, 147456, v5
    ds_add_rtn_u32 v48, v63, v7 offset:0
    s_mov_b64 exec, -1
    v_lshrrev_b32 v5, 24, v38
    v_lshlrev_b32 v5, 2, v5
    s_mov_b64 exec, s[60:61]
    v_add_u32 v63, 147456, v5
    ds_add_rtn_u32 v49, v63, v7 offset:0
    s_mov_b64 exec, -1
    v_lshrrev_b32 v5, 24, v40
    v_lshlrev_b32 v5, 2, v5
    s_mov_b64 exec, s[62:63]
    v_add_u32 v63, 147456, v5
    ds_add_rtn_u32 v50, v63, v7 offset:0
    s_mov_b64 exec, -1
    v_lshrrev_b32 v5, 24, v42
    v_lshlrev_b32 v5, 2, v5
    s_mov_b64 exec, s[64:65]
    v_add_u32 v63, 147456, v5
    ds_add_rtn_u32 v51, v63, v7 offset:0
    s_mov_b64 exec, -1
    s_waitcnt lgkmcnt(0)
    s_barrier
    s_cmp_lg_u32 s38, 0
    s_cbranch_scc1 C_scan_done
    v_lshlrev_b32 v6, 3, v0
    v_add_u32 v63, 147456, v6
    ds_read_b64 v[8:9], v63 offset:0
    s_waitcnt lgkmcnt(0)
    v_add_u32 v10, v8, v9
    v_mov_b32 v12, v10
    s_nop 1
    v_add_u32_dpp v12, v12, v12 row_shr:1 row_mask:0xf bank_mask:0xf bound_ctrl:0
    s_nop 1
    v_add_u32_dpp v12, v12, v12 row_shr:2 row_mask:0xf bank_mask:0xf bound_ctrl:0
    s_nop 1
    v_add_u32_dpp v12, v12, v12 row_shr:4 row_mask:0xf bank_mask:0xf bound_ctrl:0
    s_nop 1
    v_add_u32_dpp v12, v12, v12 row_shr:8 row_mask:0xf bank_mask:0xf bound_ctrl:0
    s_nop 1
    v_add_u32_dpp v12, v12, v12 row_bcast:15 row_mask:0xa bank_mask:0xf
    s_nop 1
    v_add_u32_dpp v12, v12, v12 row_bcast:31 row_mask:0xc bank_mask:0xf
    s_nop 1
    v_sub_u32 v12, v12, v10
    v_add_u32 v13, v12, v8
    v_add_u32 v63, 147456, v6
    ds_write_b64 v63, v[12:13] offset:512
    s_waitcnt lgkmcnt(0)
C_scan_done:
    s_barrier
    v_lshrrev_b32 v5, 24, v28
    v_lshlrev_b32 v5, 2, v5
    s_mov_b64 exec, s[50:51]
    v_add_u32 v63, 147456, v5
    ds_read_b32 v52, v63 offset:512
    s_mov_b64 exec, -1
    v_lshrrev_b32 v5, 24, v30
    v_lshlrev_b32 v5, 2, v5
    s_mov_b64 exec, s[52:53]
    v_add_u32 v63, 147456, v5
    ds_read_b32 v53, v63 offset:512
    s_mov_b64 exec, -1
    v_lshrrev_b32 v5, 24, v32
    v_lshlrev_b32 v5, 2, v5
    s_mov_b64 exec, s[54:55]
    v_add_u32 v63, 147456, v5
    ds_read_b32 v54, v63 offset:512
    s_mov_b64 exec, -1
    v_lshrrev_b32 v5, 24, v34
    v_lshlrev_b32 v5, 2, v5
    s_mov_b64 exec, s[56:57]
    v_add_u32 v63, 147456, v5
    ds_read_b32 v55, v63 offset:512
    s_mov_b64 exec, -1
    v_lshrrev_b32 v5, 24, v36
    v_lshlrev_b32 v5, 2, v5
    s_mov_b64 exec, s[58:59]
    v_add_u32 v63, 147456, v5
    ds_read_b32 v56, v63 offset:512
    s_mov_b64 exec, -1
    v_lshrrev_b32 v5, 24, v38
    v_lshlrev_b32 v5, 2, v5
    s_mov_b64 exec, s[60:61]
    v_add_u32 v63, 147456, v5
    ds_read_b32 v57, v63 offset:512
    s_mov_b64 exec, -1
    v_lshrrev_b32 v5, 24, v40
    v_lshlrev_b32 v5, 2, v5
    s_mov_b64 exec, s[62:63]
    v_add_u32 v63, 147456, v5
    ds_read_b32 v58, v63 offset:512
    s_mov_b64 exec, -1
    v_lshrrev_b32 v5, 24, v42
    v_lshlrev_b32 v5, 2, v5
    s_mov_b64 exec, s[64:65]
    v_add_u32 v63, 147456, v5
    ds_read_b32 v59, v63 offset:512
    s_mov_b64 exec, -1
    s_waitcnt lgkmcnt(0)
    v_add_u32 v5, v52, v44
    v_lshlrev_b32 v5, 3, v5
    s_mov_b64 exec, s[50:51]
    ds_write_b64 v5, v[28:29] offset:0
    s_mov_b64 exec, -1
    v_add_u32 v5, v53, v45
    v_lshlrev_b32 v5, 3, v5
    s_mov_b64 exec, s[52:53]
    ds_write_b64 v5, v[30:31] offset:0
    s_mov_b64 exec, -1
    v_add_u32 v5, v54, v46
    v_lshlrev_b32 v5, 3, v5
    s_mov_b64 exec, s[54:55]
    ds_write_b64 v5, v[32:33] offset:0
    s_mov_b64 exec, -1
    v_add_u32 v5, v55, v47
    v_lshlrev_b32 v5, 3, v5
    s_mov_b64 exec, s[56:57]
    ds_write_b64 v5, v[34:35] offset:0
    s_mov_b64 exec, -1
    v_add_u32 v5, v56, v48
    v_lshlrev_b32 v5, 3, v5
    s_mov_b64 exec, s[58:59]
    ds_write_b64 v5, v[36:37] offset:0
    s_mov_b64 exec, -1
    v_add_u32 v5, v57, v49
    v_lshlrev_b32 v5, 3, v5
    s_mov_b64 exec, s[60:61]
    ds_write_b64 v5, v[38:39] offset:0
    s_mov_b64 exec, -1
    v_add_u32 v5, v58, v50
    v_lshlrev_b32 v5, 3, v5
    s_mov_b64 exec, s[62:63]
    ds_write_b64 v5, v[40:41] offset:0
    s_mov_b64 exec, -1
    v_add_u32 v5, v59, v51
    v_lshlrev_b32 v5, 3, v5
    s_mov_b64 exec, s[64:65]
    ds_write_b64 v5, v[42:43] offset:0
    s_mov_b64 exec, -1
    s_waitcnt lgkmcnt(0)
    s_barrier
    v_lshlrev_b32 v5, 3, v3
    v_add_u32 v5, s38, v5
    v_cmp_gt_u32 vcc, 98, v5
    v_lshlrev_b32 v6, 2, v5
    v_min_u32 v6, 508, v6
    v_add_u32 v63, 147456, v6
    ds_read_b32 v8, v63 offset:512
    v_add_u32 v63, 147456, v6
    ds_read_b32 v9, v63 offset:0
    s_waitcnt lgkmcnt(0)
    s_nop 1
    v_cndmask_b32 v9, 0, v9, vcc
    v_add_u32 v10, 15, v9
    v_lshrrev_b32 v10, 4, v10
    v_mov_b32 v11, v10
    s_nop 1
    v_add_u32_dpp v11, v11, v11 row_shr:1 row_mask:0xf bank_mask:0xf bound_ctrl:0
    s_nop 1
    v_add_u32_dpp v11, v11, v11 row_shr:2 row_mask:0xf bank_mask:0xf bound_ctrl:0
    s_nop 1
    v_add_u32_dpp v11, v11, v11 row_shr:4 row_mask:0xf bank_mask:0xf bound_ctrl:0
    s_nop 1
    v_add_u32_dpp v11, v11, v11 row_shr:8 row_mask:0xf bank_mask:0xf bound_ctrl:0
    s_nop 1
    v_add_u32_dpp v11, v11, v11 row_bcast:15 row_mask:0xa bank_mask:0xf
    s_nop 1
    v_add_u32_dpp v11, v11, v11 row_bcast:31 row_mask:0xc bank_mask:0xf
    s_nop 1
    s_nop 0
    v_readlane_b32 s44, v11, 63
    v_sub_u32 v11, v11, v10
    s_mul_i32 s45, s38, 1536
    s_add_u32 s45, s45, 148736
    v_lshlrev_b32 v11, 2, v11
    v_add_u32 v11, s45, v11
    v_mov_b32 v12, 0
    v_lshlrev_b32 v13, 17, v5
C_tl_loop:
    v_cmp_lt_u32 vcc, v12, v10
    s_cbranch_vccz C_tl_done
    s_and_saveexec_b64 s[50:51], vcc
    v_lshlrev_b32 v14, 4, v12
    v_sub_u32 v15, v9, v14
    v_min_u32 v15, 16, v15
    v_add_u32 v14, v14, v8
    v_lshl_or_b32 v14, v15, 12, v14
    v_or_b32 v14, v14, v13
    v_cmp_eq_u32 vcc, 0, v12
    s_nop 1
    v_cndmask_b32 v15, 0, 1, vcc
    v_lshl_or_b32 v14, v15, 24, v14
    v_add_u32 v15, 1, v12
    v_cmp_eq_u32 vcc, v15, v10
    s_nop 1
    v_cndmask_b32 v15, 0, 1, vcc
    v_lshl_or_b32 v14, v15, 25, v14
    ds_write_b32 v11, v14
    v_add_u32 v11, 4, v11
    v_add_u32 v12, 1, v12
    s_mov_b64 exec, -1
    s_branch C_tl_loop
C_tl_done:
    s_waitcnt lgkmcnt(0)
    v_lshl_add_u32 v16, v2, 2, 0
    v_lshl_add_u32 v17, v2, 2, 1
    v_lshl_add_u32 v18, v2, 2, 2
    v_lshl_add_u32 v19, v2, 2, 3
    v_mov_b32 v58, v21
    v_mov_b32 v59, v22
    v_mov_b32 v60, v23
    v_lshlrev_b32 v20, 2, v1
    v_add_u32 v20, 90112, v20
    v_lshlrev_b32 v21, 2, v1
    v_add_u32 v21, 32768, v21
    v_lshlrev_b32 v22, 4, v2
    v_lshlrev_b32 v23, 3, v2
    v_mov_b32 v24, s45
    v_mov_b32 v204, 0
    v_mov_b32 v220, 0
    v_mov_b32 v205, 0
    v_mov_b32 v221, 0
    v_mov_b32 v206, 0
    v_mov_b32 v222, 0
    v_mov_b32 v207, 0
    v_mov_b32 v223, 0
    v_mov_b32 v208, 0
    v_mov_b32 v224, 0
    v_mov_b32 v209, 0
    v_mov_b32 v225, 0
    v_mov_b32 v210, 0
    v_mov_b32 v226, 0
    v_mov_b32 v211, 0
    v_mov_b32 v227, 0
    v_mov_b32 v212, 0
    v_mov_b32 v228, 0
    v_mov_b32 v213, 0
    v_mov_b32 v229, 0
    v_mov_b32 v214, 0
    v_mov_b32 v230, 0
    v_mov_b32 v215, 0
    v_mov_b32 v231, 0
    v_mov_b32 v216, 0
    v_mov_b32 v232, 0
    v_mov_b32 v217, 0
    v_mov_b32 v233, 0
    v_mov_b32 v218, 0
    v_mov_b32 v234, 0
    v_mov_b32 v219, 0
    v_mov_b32 v235, 0
    s_cmp_eq_u32 s44, 0
    s_cbranch_scc1 C_loop_end
    ds_read_b32 v25, v24
    v_add_u32 v24, 4, v24
    s_mov_b32 s46, 0
    s_mov_b32 s88, 0
    s_waitcnt lgkmcnt(0)
    s_nop 0
    v_readfirstlane_b32 s62, v25
    ds_read_b32 v25, v24
    v_add_u32 v24, 4, v24
    s_bfe_u32 s63, s62, 0x5000c
    s_and_b32 s64, s62, 0xfff
    s_sub_u32 s63, s63, 1
    v_min_u32 v26, s63, v1
    v_add_u32 v26, s64, v26
    v_lshlrev_b32 v26, 3, v26
    ds_read_b64 v[26:27], v26 offset:0
    s_waitcnt lgkmcnt(0)
    s_nop 0
    v_readfirstlane_b32 s67, v25
    ds_read_b32 v25, v24
    v_add_u32 v24, 4, v24
    s_waitcnt lgkmcnt(0)
    v_lshl_add_u32 v29, v27, 7, v22
    v_and_b32 v30, 0xfffff, v26
    v_lshl_add_u32 v30, v30, 5, v23
    s_nop 0
    v_readfirstlane_b32 s68, v25
    buffer_load_dwordx4 v[136:139], v29, s[12:15], 0 offen
    buffer_load_dwordx4 v[140:143], v29, s[12:15], 0 offen offset:64
    buffer_load_dwordx2 v[144:145], v30, s[24:27], 0 offen
    s_bfe_u32 s63, s67, 0x5000c
    s_and_b32 s64, s67, 0xfff
    s_sub_u32 s63, s63, 1
    v_min_u32 v26, s63, v1
    v_add_u32 v26, s64, v26
    v_lshlrev_b32 v26, 3, v26
    ds_read_b64 v[26:27], v26 offset:0
    ds_read_b32 v25, v24
    v_add_u32 v24, 4, v24
    s_mov_b32 s60, s61
    s_mov_b32 s61, s62
    s_mov_b32 s62, s67
    s_mov_b32 s67, s68
    s_waitcnt lgkmcnt(0)
    v_lshl_add_u32 v29, v27, 7, v22
    v_and_b32 v30, 0xfffff, v26
    v_lshl_add_u32 v30, v30, 5, v23
    s_nop 0
    v_readfirstlane_b32 s68, v25
    buffer_load_dwordx4 v[148:151], v29, s[12:15], 0 offen
    buffer_load_dwordx4 v[152:155], v29, s[12:15], 0 offen offset:64
    buffer_load_dwordx2 v[156:157], v30, s[24:27], 0 offen
    s_bfe_u32 s63, s67, 0x5000c
    s_and_b32 s64, s67, 0xfff
    s_sub_u32 s63, s63, 1
    v_min_u32 v26, s63, v1
    v_add_u32 v26, s64, v26
    v_lshlrev_b32 v26, 3, v26
    ds_read_b64 v[26:27], v26 offset:0
    ds_read_b32 v25, v24
    v_add_u32 v24, 4, v24
    s_mov_b32 s60, s61
    s_mov_b32 s61, s62
    s_mov_b32 s62, s67
    s_mov_b32 s67, s68
C_loop:
    s_waitcnt lgkmcnt(0)
    v_lshl_add_u32 v29, v27, 7, v22
    v_and_b32 v30, 0xfffff, v26
    v_lshl_add_u32 v30, v30, 5, v23
    s_nop 0
    v_readfirstlane_b32 s68, v25
    buffer_load_dwordx4 v[160:163], v29, s[12:15], 0 offen
    buffer_load_dwordx4 v[164:167], v29, s[12:15], 0 offen offset:64
    buffer_load_dwordx2 v[168:169], v30, s[24:27], 0 offen
    s_bfe_u32 s63, s67, 0x5000c
    s_and_b32 s64, s67, 0xfff
    s_sub_u32 s63, s63, 1
    v_min_u32 v26, s63, v1
    v_add_u32 v26, s64, v26
    v_lshlrev_b32 v26, 3, v26
    ds_read_b64 v[26:27], v26 offset:0
    ds_read_b32 v25, v24
    v_add_u32 v24, 4, v24
    s_bitcmp1_b32 s60, 24
    s_cbranch_scc0 C_nf0
    s_bfe_u32 s65, s60, 0x70011
    s_lshl_b32 s65, s65, 8
    v_add_u32 v28, s65, v20
    ds_read_b32 v236, v28 offset:0
    ds_read_b32 v237, v28 offset:0
    ds_read_b32 v238, v28 offset:0
    ds_read_b32 v239, v28 offset:0
    ds_read_b32 v240, v28 offset:64
    ds_read_b32 v241, v28 offset:64
    ds_read_b32 v242, v28 offset:64
    ds_read_b32 v243, v28 offset:64
    ds_read_b32 v244, v28 offset:128
    ds_read_b32 v245, v28 offset:128
    ds_read_b32 v246, v28 offset:128
    ds_read_b32 v247, v28 offset:128
    ds_read_b32 v248, v28 offset:192
    ds_read_b32 v249, v28 offset:192
    ds_read_b32 v250, v28 offset:192
    ds_read_b32 v251, v28 offset:192
    s_waitcnt lgkmcnt(0)
C_nf0:
    s_bfe_u32 s66, s60, 0x5000c
    v_cmp_gt_u32 s[50:51], s66, v16
    v_cmp_gt_u32 s[52:53], s66, v17
    v_cmp_gt_u32 s[54:55], s66, v18
    v_cmp_gt_u32 s[56:57], s66, v19
    s_waitcnt vmcnt(6)
    v_mfma_f32_16x16x16_bf16 v[172:175], v[144:145], v[128:129], v[236:239]
    v_mfma_f32_16x16x16_bf16 v[176:179], v[144:145], v[130:131], v[240:243]
    v_mfma_f32_16x16x16_bf16 v[180:183], v[144:145], v[132:133], v[244:247]
    v_mfma_f32_16x16x16_bf16 v[184:187], v[144:145], v[134:135], v[248:251]
    v_mfma_f32_16x16x32_bf16 v[188:191], v[136:139], v[96:99], 0
    v_mfma_f32_16x16x32_bf16 v[192:195], v[136:139], v[104:107], 0
    v_mfma_f32_16x16x32_bf16 v[196:199], v[136:139], v[112:115], 0
    v_mfma_f32_16x16x32_bf16 v[200:203], v[136:139], v[120:123], 0
    v_mfma_f32_16x16x32_bf16 v[172:175], v[136:139], v[64:67], v[172:175]
    v_mfma_f32_16x16x32_bf16 v[176:179], v[136:139], v[72:75], v[176:179]
    v_mfma_f32_16x16x32_bf16 v[180:183], v[136:139], v[80:83], v[180:183]
    v_mfma_f32_16x16x32_bf16 v[184:187], v[136:139], v[88:91], v[184:187]
    v_mfma_f32_16x16x32_bf16 v[188:191], v[140:143], v[100:103], v[188:191]
    v_mfma_f32_16x16x32_bf16 v[192:195], v[140:143], v[108:111], v[192:195]
    v_mfma_f32_16x16x32_bf16 v[196:199], v[140:143], v[116:119], v[196:199]
    v_mfma_f32_16x16x32_bf16 v[200:203], v[140:143], v[124:127], v[200:203]
    v_mfma_f32_16x16x32_bf16 v[172:175], v[140:143], v[68:71], v[172:175]
    v_mfma_f32_16x16x32_bf16 v[176:179], v[140:143], v[76:79], v[176:179]
    v_mfma_f32_16x16x32_bf16 v[180:183], v[140:143], v[84:87], v[180:183]
    v_mfma_f32_16x16x32_bf16 v[184:187], v[140:143], v[92:95], v[184:187]
    s_nop 7
    v_mul_f32 v172, 0xbfb8aa3b, v172
    v_mul_f32 v173, 0xbfb8aa3b, v173
    v_mul_f32 v174, 0xbfb8aa3b, v174
    v_mul_f32 v175, 0xbfb8aa3b, v175
    v_mul_f32 v176, 0xbfb8aa3b, v176
    v_mul_f32 v177, 0xbfb8aa3b, v177
    v_mul_f32 v178, 0xbfb8aa3b, v178
    v_mul_f32 v179, 0xbfb8aa3b, v179
    v_mul_f32 v180, 0xbfb8aa3b, v180
    v_mul_f32 v181, 0xbfb8aa3b, v181
    v_mul_f32 v182, 0xbfb8aa3b, v182
    v_mul_f32 v183, 0xbfb8aa3b, v183
    v_mul_f32 v184, 0xbfb8aa3b, v184
    v_mul_f32 v185, 0xbfb8aa3b, v185
    v_mul_f32 v186, 0xbfb8aa3b, v186
    v_mul_f32 v187, 0xbfb8aa3b, v187
    v_exp_f32 v172, v172
    v_exp_f32 v173, v173
    v_exp_f32 v174, v174
    v_exp_f32 v175, v175
    v_exp_f32 v176, v176
    v_exp_f32 v177, v177
    v_exp_f32 v178, v178
    v_exp_f32 v179, v179
    v_exp_f32 v180, v180
    v_exp_f32 v181, v181
    v_exp_f32 v182, v182
    v_exp_f32 v183, v183
    v_exp_f32 v184, v184
    v_exp_f32 v185, v185
    v_exp_f32 v186, v186
    v_exp_f32 v187, v187
    v_add_f32 v172, 1.0, v172
    v_add_f32 v173, 1.0, v173
    v_add_f32 v174, 1.0, v174
    v_add_f32 v175, 1.0, v175
    v_add_f32 v176, 1.0, v176
    v_add_f32 v177, 1.0, v177
    v_add_f32 v178, 1.0, v178
    v_add_f32 v179, 1.0, v179
    v_add_f32 v180, 1.0, v180
    v_add_f32 v181, 1.0, v181
    v_add_f32 v182, 1.0, v182
    v_add_f32 v183, 1.0, v183
    v_add_f32 v184, 1.0, v184
    v_add_f32 v185, 1.0, v185
    v_add_f32 v186, 1.0, v186
    v_add_f32 v187, 1.0, v187
    v_rcp_f32 v172, v172
    v_rcp_f32 v173, v173
    v_rcp_f32 v174, v174
    v_rcp_f32 v175, v175
    v_rcp_f32 v176, v176
    v_rcp_f32 v177, v177
    v_rcp_f32 v178, v178
    v_rcp_f32 v179, v179
    v_rcp_f32 v180, v180
    v_rcp_f32 v181, v181
    v_rcp_f32 v182, v182
    v_rcp_f32 v183, v183
    v_rcp_f32 v184, v184
    v_rcp_f32 v185, v185
    v_rcp_f32 v186, v186
    v_rcp_f32 v187, v187
    s_nop 0
    s_mov_b64 exec, s[50:51]
    v_add_f32 v204, v204, v172
    v_fmac_f32 v220, v172, v188
    v_add_f32 v208, v208, v176
    v_fmac_f32 v224, v176, v192
    v_add_f32 v212, v212, v180
    v_fmac_f32 v228, v180, v196
    v_add_f32 v216, v216, v184
    v_fmac_f32 v232, v184, v200
    s_mov_b64 exec, s[52:53]
    v_add_f32 v205, v205, v173
    v_fmac_f32 v221, v173, v189
    v_add_f32 v209, v209, v177
    v_fmac_f32 v225, v177, v193
    v_add_f32 v213, v213, v181
    v_fmac_f32 v229, v181, v197
    v_add_f32 v217, v217, v185
    v_fmac_f32 v233, v185, v201
    s_mov_b64 exec, s[54:55]
    v_add_f32 v206, v206, v174
    v_fmac_f32 v222, v174, v190
    v_add_f32 v210, v210, v178
    v_fmac_f32 v226, v178, v194
    v_add_f32 v214, v214, v182
    v_fmac_f32 v230, v182, v198
    v_add_f32 v218, v218, v186
    v_fmac_f32 v234, v186, v202
    s_mov_b64 exec, s[56:57]
    v_add_f32 v207, v207, v175
    v_fmac_f32 v223, v175, v191
    v_add_f32 v211, v211, v179
    v_fmac_f32 v227, v179, v195
    v_add_f32 v215, v215, v183
    v_fmac_f32 v231, v183, v199
    v_add_f32 v219, v219, v187
    v_fmac_f32 v235, v187, v203
    s_mov_b64 exec, -1
    s_bitcmp1_b32 s60, 25
    s_cbranch_scc0 C_nl0
    s_bfe_u32 s65, s60, 0x70011
    s_lshl_b32 s65, s65, 9
    v_add_u32 v28, s65, v21
    ds_read_b32 v30, v28 offset:0
    ds_read_b32 v31, v28 offset:64
    ds_read_b32 v32, v28 offset:128
    ds_read_b32 v33, v28 offset:192
    ds_read_b32 v34, v28 offset:256
    ds_read_b32 v35, v28 offset:320
    ds_read_b32 v36, v28 offset:384
    ds_read_b32 v37, v28 offset:448
    v_add_f32 v204, v204, v205
    v_add_f32 v206, v206, v207
    v_add_f32 v208, v208, v209
    v_add_f32 v210, v210, v211
    v_add_f32 v212, v212, v213
    v_add_f32 v214, v214, v215
    v_add_f32 v216, v216, v217
    v_add_f32 v218, v218, v219
    v_add_f32 v220, v220, v221
    v_add_f32 v222, v222, v223
    v_add_f32 v224, v224, v225
    v_add_f32 v226, v226, v227
    v_add_f32 v228, v228, v229
    v_add_f32 v230, v230, v231
    v_add_f32 v232, v232, v233
    v_add_f32 v234, v234, v235
    v_add_f32 v204, v204, v206
    v_add_f32 v208, v208, v210
    v_add_f32 v212, v212, v214
    v_add_f32 v216, v216, v218
    v_add_f32 v220, v220, v222
    v_add_f32 v224, v224, v226
    v_add_f32 v228, v228, v230
    v_add_f32 v232, v232, v234
    v_mov_b32 v205, v204
    v_mov_b32 v209, v208
    v_mov_b32 v213, v212
    v_mov_b32 v217, v216
    v_mov_b32 v221, v220
    v_mov_b32 v225, v224
    v_mov_b32 v229, v228
    v_mov_b32 v233, v232
    s_nop 1
    v_permlane32_swap_b32 v204, v205
    v_permlane32_swap_b32 v208, v209
    v_permlane32_swap_b32 v212, v213
    v_permlane32_swap_b32 v216, v217
    v_permlane32_swap_b32 v220, v221
    v_permlane32_swap_b32 v224, v225
    v_permlane32_swap_b32 v228, v229
    v_permlane32_swap_b32 v232, v233
    v_add_f32 v204, v204, v205
    v_add_f32 v208, v208, v209
    v_add_f32 v212, v212, v213
    v_add_f32 v216, v216, v217
    v_add_f32 v220, v220, v221
    v_add_f32 v224, v224, v225
    v_add_f32 v228, v228, v229
    v_add_f32 v232, v232, v233
    v_mov_b32 v205, v204
    v_mov_b32 v209, v208
    v_mov_b32 v213, v212
    v_mov_b32 v217, v216
    v_mov_b32 v221, v220
    v_mov_b32 v225, v224
    v_mov_b32 v229, v228
    v_mov_b32 v233, v232
    s_nop 1
    v_permlane16_swap_b32 v204, v205
    v_permlane16_swap_b32 v208, v209
    v_permlane16_swap_b32 v212, v213
    v_permlane16_swap_b32 v216, v217
    v_permlane16_swap_b32 v220, v221
    v_permlane16_swap_b32 v224, v225
    v_permlane16_swap_b32 v228, v229
    v_permlane16_swap_b32 v232, v233
    s_waitcnt lgkmcnt(0)
    v_add_f32 v204, v204, v205
    v_add_f32 v204, v204, v30
    v_add_f32 v208, v208, v209
    v_add_f32 v208, v208, v31
    v_add_f32 v212, v212, v213
    v_add_f32 v212, v212, v32
    v_add_f32 v216, v216, v217
    v_add_f32 v216, v216, v33
    v_add_f32 v220, v220, v221
    v_add_f32 v220, v220, v34
    v_add_f32 v224, v224, v225
    v_add_f32 v224, v224, v35
    v_add_f32 v228, v228, v229
    v_add_f32 v228, v228, v36
    v_add_f32 v232, v232, v233
    v_add_f32 v232, v232, v37
    ds_write_b32 v28, v204 offset:0
    ds_write_b32 v28, v208 offset:64
    ds_write_b32 v28, v212 offset:128
    ds_write_b32 v28, v216 offset:192
    ds_write_b32 v28, v220 offset:256
    ds_write_b32 v28, v224 offset:320
    ds_write_b32 v28, v228 offset:384
    ds_write_b32 v28, v232 offset:448
    v_mov_b32 v204, 0
    v_mov_b32 v220, 0
    v_mov_b32 v205, 0
    v_mov_b32 v221, 0
    v_mov_b32 v206, 0
    v_mov_b32 v222, 0
    v_mov_b32 v207, 0
    v_mov_b32 v223, 0
    v_mov_b32 v208, 0
    v_mov_b32 v224, 0
    v_mov_b32 v209, 0
    v_mov_b32 v225, 0
    v_mov_b32 v210, 0
    v_mov_b32 v226, 0
    v_mov_b32 v211, 0
    v_mov_b32 v227, 0
    v_mov_b32 v212, 0
    v_mov_b32 v228, 0
    v_mov_b32 v213, 0
    v_mov_b32 v229, 0
    v_mov_b32 v214, 0
    v_mov_b32 v230, 0
    v_mov_b32 v215, 0
    v_mov_b32 v231, 0
    v_mov_b32 v216, 0
    v_mov_b32 v232, 0
    v_mov_b32 v217, 0
    v_mov_b32 v233, 0
    v_mov_b32 v218, 0
    v_mov_b32 v234, 0
    v_mov_b32 v219, 0
    v_mov_b32 v235, 0
C_nl0:
    s_mov_b32 s60, s61
    s_mov_b32 s61, s62
    s_mov_b32 s62, s67
    s_mov_b32 s67, s68
    s_add_u32 s46, s46, 1
    s_cmp_ge_u32 s46, s44
    s_cbranch_scc1 C_loop_end
    s_waitcnt lgkmcnt(0)
    v_lshl_add_u32 v29, v27, 7, v22
    v_and_b32 v30, 0xfffff, v26
    v_lshl_add_u32 v30, v30, 5, v23
    s_nop 0
    v_readfirstlane_b32 s68, v25
    buffer_load_dwordx4 v[136:139], v29, s[12:15], 0 offen
    buffer_load_dwordx4 v[140:143], v29, s[12:15], 0 offen offset:64
    buffer_load_dwordx2 v[144:145], v30, s[24:27], 0 offen
    s_bfe_u32 s63, s67, 0x5000c
    s_and_b32 s64, s67, 0xfff
    s_sub_u32 s63, s63, 1
    v_min_u32 v26, s63, v1
    v_add_u32 v26, s64, v26
    v_lshlrev_b32 v26, 3, v26
    ds_read_b64 v[26:27], v26 offset:0
    ds_read_b32 v25, v24
    v_add_u32 v24, 4, v24
    s_bitcmp1_b32 s60, 24
    s_cbranch_scc0 C_nf1
    s_bfe_u32 s65, s60, 0x70011
    s_lshl_b32 s65, s65, 8
    v_add_u32 v28, s65, v20
    ds_read_b32 v236, v28 offset:0
    ds_read_b32 v237, v28 offset:0
    ds_read_b32 v238, v28 offset:0
    ds_read_b32 v239, v28 offset:0
    ds_read_b32 v240, v28 offset:64
    ds_read_b32 v241, v28 offset:64
    ds_read_b32 v242, v28 offset:64
    ds_read_b32 v243, v28 offset:64
    ds_read_b32 v244, v28 offset:128
    ds_read_b32 v245, v28 offset:128
    ds_read_b32 v246, v28 offset:128
    ds_read_b32 v247, v28 offset:128
    ds_read_b32 v248, v28 offset:192
    ds_read_b32 v249, v28 offset:192
    ds_read_b32 v250, v28 offset:192
    ds_read_b32 v251, v28 offset:192
    s_waitcnt lgkmcnt(0)
C_nf1:
    s_bfe_u32 s66, s60, 0x5000c
    v_cmp_gt_u32 s[50:51], s66, v16
    v_cmp_gt_u32 s[52:53], s66, v17
    v_cmp_gt_u32 s[54:55], s66, v18
    v_cmp_gt_u32 s[56:57], s66, v19
    s_waitcnt vmcnt(6)
    v_mfma_f32_16x16x16_bf16 v[172:175], v[156:157], v[128:129], v[236:239]
    v_mfma_f32_16x16x16_bf16 v[176:179], v[156:157], v[130:131], v[240:243]
    v_mfma_f32_16x16x16_bf16 v[180:183], v[156:157], v[132:133], v[244:247]
    v_mfma_f32_16x16x16_bf16 v[184:187], v[156:157], v[134:135], v[248:251]
    v_mfma_f32_16x16x32_bf16 v[188:191], v[148:151], v[96:99], 0
    v_mfma_f32_16x16x32_bf16 v[192:195], v[148:151], v[104:107], 0
    v_mfma_f32_16x16x32_bf16 v[196:199], v[148:151], v[112:115], 0
    v_mfma_f32_16x16x32_bf16 v[200:203], v[148:151], v[120:123], 0
    v_mfma_f32_16x16x32_bf16 v[172:175], v[148:151], v[64:67], v[172:175]
    v_mfma_f32_16x16x32_bf16 v[176:179], v[148:151], v[72:75], v[176:179]
    v_mfma_f32_16x16x32_bf16 v[180:183], v[148:151], v[80:83], v[180:183]
    v_mfma_f32_16x16x32_bf16 v[184:187], v[148:151], v[88:91], v[184:187]
    v_mfma_f32_16x16x32_bf16 v[188:191], v[152:155], v[100:103], v[188:191]
    v_mfma_f32_16x16x32_bf16 v[192:195], v[152:155], v[108:111], v[192:195]
    v_mfma_f32_16x16x32_bf16 v[196:199], v[152:155], v[116:119], v[196:199]
    v_mfma_f32_16x16x32_bf16 v[200:203], v[152:155], v[124:127], v[200:203]
    v_mfma_f32_16x16x32_bf16 v[172:175], v[152:155], v[68:71], v[172:175]
    v_mfma_f32_16x16x32_bf16 v[176:179], v[152:155], v[76:79], v[176:179]
    v_mfma_f32_16x16x32_bf16 v[180:183], v[152:155], v[84:87], v[180:183]
    v_mfma_f32_16x16x32_bf16 v[184:187], v[152:155], v[92:95], v[184:187]
    s_nop 7
    v_mul_f32 v172, 0xbfb8aa3b, v172
    v_mul_f32 v173, 0xbfb8aa3b, v173
    v_mul_f32 v174, 0xbfb8aa3b, v174
    v_mul_f32 v175, 0xbfb8aa3b, v175
    v_mul_f32 v176, 0xbfb8aa3b, v176
    v_mul_f32 v177, 0xbfb8aa3b, v177
    v_mul_f32 v178, 0xbfb8aa3b, v178
    v_mul_f32 v179, 0xbfb8aa3b, v179
    v_mul_f32 v180, 0xbfb8aa3b, v180
    v_mul_f32 v181, 0xbfb8aa3b, v181
    v_mul_f32 v182, 0xbfb8aa3b, v182
    v_mul_f32 v183, 0xbfb8aa3b, v183
    v_mul_f32 v184, 0xbfb8aa3b, v184
    v_mul_f32 v185, 0xbfb8aa3b, v185
    v_mul_f32 v186, 0xbfb8aa3b, v186
    v_mul_f32 v187, 0xbfb8aa3b, v187
    v_exp_f32 v172, v172
    v_exp_f32 v173, v173
    v_exp_f32 v174, v174
    v_exp_f32 v175, v175
    v_exp_f32 v176, v176
    v_exp_f32 v177, v177
    v_exp_f32 v178, v178
    v_exp_f32 v179, v179
    v_exp_f32 v180, v180
    v_exp_f32 v181, v181
    v_exp_f32 v182, v182
    v_exp_f32 v183, v183
    v_exp_f32 v184, v184
    v_exp_f32 v185, v185
    v_exp_f32 v186, v186
    v_exp_f32 v187, v187
    v_add_f32 v172, 1.0, v172
    v_add_f32 v173, 1.0, v173
    v_add_f32 v174, 1.0, v174
    v_add_f32 v175, 1.0, v175
    v_add_f32 v176, 1.0, v176
    v_add_f32 v177, 1.0, v177
    v_add_f32 v178, 1.0, v178
    v_add_f32 v179, 1.0, v179
    v_add_f32 v180, 1.0, v180
    v_add_f32 v181, 1.0, v181
    v_add_f32 v182, 1.0, v182
    v_add_f32 v183, 1.0, v183
    v_add_f32 v184, 1.0, v184
    v_add_f32 v185, 1.0, v185
    v_add_f32 v186, 1.0, v186
    v_add_f32 v187, 1.0, v187
    v_rcp_f32 v172, v172
    v_rcp_f32 v173, v173
    v_rcp_f32 v174, v174
    v_rcp_f32 v175, v175
    v_rcp_f32 v176, v176
    v_rcp_f32 v177, v177
    v_rcp_f32 v178, v178
    v_rcp_f32 v179, v179
    v_rcp_f32 v180, v180
    v_rcp_f32 v181, v181
    v_rcp_f32 v182, v182
    v_rcp_f32 v183, v183
    v_rcp_f32 v184, v184
    v_rcp_f32 v185, v185
    v_rcp_f32 v186, v186
    v_rcp_f32 v187, v187
    s_nop 0
    s_mov_b64 exec, s[50:51]
    v_add_f32 v204, v204, v172
    v_fmac_f32 v220, v172, v188
    v_add_f32 v208, v208, v176
    v_fmac_f32 v224, v176, v192
    v_add_f32 v212, v212, v180
    v_fmac_f32 v228, v180, v196
    v_add_f32 v216, v216, v184
    v_fmac_f32 v232, v184, v200
    s_mov_b64 exec, s[52:53]
    v_add_f32 v205, v205, v173
    v_fmac_f32 v221, v173, v189
    v_add_f32 v209, v209, v177
    v_fmac_f32 v225, v177, v193
    v_add_f32 v213, v213, v181
    v_fmac_f32 v229, v181, v197
    v_add_f32 v217, v217, v185
    v_fmac_f32 v233, v185, v201
    s_mov_b64 exec, s[54:55]
    v_add_f32 v206, v206, v174
    v_fmac_f32 v222, v174, v190
    v_add_f32 v210, v210, v178
    v_fmac_f32 v226, v178, v194
    v_add_f32 v214, v214, v182
    v_fmac_f32 v230, v182, v198
    v_add_f32 v218, v218, v186
    v_fmac_f32 v234, v186, v202
    s_mov_b64 exec, s[56:57]
    v_add_f32 v207, v207, v175
    v_fmac_f32 v223, v175, v191
    v_add_f32 v211, v211, v179
    v_fmac_f32 v227, v179, v195
    v_add_f32 v215, v215, v183
    v_fmac_f32 v231, v183, v199
    v_add_f32 v219, v219, v187
    v_fmac_f32 v235, v187, v203
    s_mov_b64 exec, -1
    s_bitcmp1_b32 s60, 25
    s_cbranch_scc0 C_nl1
    s_bfe_u32 s65, s60, 0x70011
    s_lshl_b32 s65, s65, 9
    v_add_u32 v28, s65, v21
    ds_read_b32 v30, v28 offset:0
    ds_read_b32 v31, v28 offset:64
    ds_read_b32 v32, v28 offset:128
    ds_read_b32 v33, v28 offset:192
    ds_read_b32 v34, v28 offset:256
    ds_read_b32 v35, v28 offset:320
    ds_read_b32 v36, v28 offset:384
    ds_read_b32 v37, v28 offset:448
    v_add_f32 v204, v204, v205
    v_add_f32 v206, v206, v207
    v_add_f32 v208, v208, v209
    v_add_f32 v210, v210, v211
    v_add_f32 v212, v212, v213
    v_add_f32 v214, v214, v215
    v_add_f32 v216, v216, v217
    v_add_f32 v218, v218, v219
    v_add_f32 v220, v220, v221
    v_add_f32 v222, v222, v223
    v_add_f32 v224, v224, v225
    v_add_f32 v226, v226, v227
    v_add_f32 v228, v228, v229
    v_add_f32 v230, v230, v231
    v_add_f32 v232, v232, v233
    v_add_f32 v234, v234, v235
    v_add_f32 v204, v204, v206
    v_add_f32 v208, v208, v210
    v_add_f32 v212, v212, v214
    v_add_f32 v216, v216, v218
    v_add_f32 v220, v220, v222
    v_add_f32 v224, v224, v226
    v_add_f32 v228, v228, v230
    v_add_f32 v232, v232, v234
    v_mov_b32 v205, v204
    v_mov_b32 v209, v208
    v_mov_b32 v213, v212
    v_mov_b32 v217, v216
    v_mov_b32 v221, v220
    v_mov_b32 v225, v224
    v_mov_b32 v229, v228
    v_mov_b32 v233, v232
    s_nop 1
    v_permlane32_swap_b32 v204, v205
    v_permlane32_swap_b32 v208, v209
    v_permlane32_swap_b32 v212, v213
    v_permlane32_swap_b32 v216, v217
    v_permlane32_swap_b32 v220, v221
    v_permlane32_swap_b32 v224, v225
    v_permlane32_swap_b32 v228, v229
    v_permlane32_swap_b32 v232, v233
    v_add_f32 v204, v204, v205
    v_add_f32 v208, v208, v209
    v_add_f32 v212, v212, v213
    v_add_f32 v216, v216, v217
    v_add_f32 v220, v220, v221
    v_add_f32 v224, v224, v225
    v_add_f32 v228, v228, v229
    v_add_f32 v232, v232, v233
    v_mov_b32 v205, v204
    v_mov_b32 v209, v208
    v_mov_b32 v213, v212
    v_mov_b32 v217, v216
    v_mov_b32 v221, v220
    v_mov_b32 v225, v224
    v_mov_b32 v229, v228
    v_mov_b32 v233, v232
    s_nop 1
    v_permlane16_swap_b32 v204, v205
    v_permlane16_swap_b32 v208, v209
    v_permlane16_swap_b32 v212, v213
    v_permlane16_swap_b32 v216, v217
    v_permlane16_swap_b32 v220, v221
    v_permlane16_swap_b32 v224, v225
    v_permlane16_swap_b32 v228, v229
    v_permlane16_swap_b32 v232, v233
    s_waitcnt lgkmcnt(0)
    v_add_f32 v204, v204, v205
    v_add_f32 v204, v204, v30
    v_add_f32 v208, v208, v209
    v_add_f32 v208, v208, v31
    v_add_f32 v212, v212, v213
    v_add_f32 v212, v212, v32
    v_add_f32 v216, v216, v217
    v_add_f32 v216, v216, v33
    v_add_f32 v220, v220, v221
    v_add_f32 v220, v220, v34
    v_add_f32 v224, v224, v225
    v_add_f32 v224, v224, v35
    v_add_f32 v228, v228, v229
    v_add_f32 v228, v228, v36
    v_add_f32 v232, v232, v233
    v_add_f32 v232, v232, v37
    ds_write_b32 v28, v204 offset:0
    ds_write_b32 v28, v208 offset:64
    ds_write_b32 v28, v212 offset:128
    ds_write_b32 v28, v216 offset:192
    ds_write_b32 v28, v220 offset:256
    ds_write_b32 v28, v224 offset:320
    ds_write_b32 v28, v228 offset:384
    ds_write_b32 v28, v232 offset:448
    v_mov_b32 v204, 0
    v_mov_b32 v220, 0
    v_mov_b32 v205, 0
    v_mov_b32 v221, 0
    v_mov_b32 v206, 0
    v_mov_b32 v222, 0
    v_mov_b32 v207, 0
    v_mov_b32 v223, 0
    v_mov_b32 v208, 0
    v_mov_b32 v224, 0
    v_mov_b32 v209, 0
    v_mov_b32 v225, 0
    v_mov_b32 v210, 0
    v_mov_b32 v226, 0
    v_mov_b32 v211, 0
    v_mov_b32 v227, 0
    v_mov_b32 v212, 0
    v_mov_b32 v228, 0
    v_mov_b32 v213, 0
    v_mov_b32 v229, 0
    v_mov_b32 v214, 0
    v_mov_b32 v230, 0
    v_mov_b32 v215, 0
    v_mov_b32 v231, 0
    v_mov_b32 v216, 0
    v_mov_b32 v232, 0
    v_mov_b32 v217, 0
    v_mov_b32 v233, 0
    v_mov_b32 v218, 0
    v_mov_b32 v234, 0
    v_mov_b32 v219, 0
    v_mov_b32 v235, 0
C_nl1:
    s_mov_b32 s60, s61
    s_mov_b32 s61, s62
    s_mov_b32 s62, s67
    s_mov_b32 s67, s68
    s_add_u32 s46, s46, 1
    s_cmp_ge_u32 s46, s44
    s_cbranch_scc1 C_loop_end
    s_waitcnt lgkmcnt(0)
    v_lshl_add_u32 v29, v27, 7, v22
    v_and_b32 v30, 0xfffff, v26
    v_lshl_add_u32 v30, v30, 5, v23
    s_nop 0
    v_readfirstlane_b32 s68, v25
    buffer_load_dwordx4 v[148:151], v29, s[12:15], 0 offen
    buffer_load_dwordx4 v[152:155], v29, s[12:15], 0 offen offset:64
    buffer_load_dwordx2 v[156:157], v30, s[24:27], 0 offen
    s_bfe_u32 s63, s67, 0x5000c
    s_and_b32 s64, s67, 0xfff
    s_sub_u32 s63, s63, 1
    v_min_u32 v26, s63, v1
    v_add_u32 v26, s64, v26
    v_lshlrev_b32 v26, 3, v26
    ds_read_b64 v[26:27], v26 offset:0
    ds_read_b32 v25, v24
    v_add_u32 v24, 4, v24
    s_bitcmp1_b32 s60, 24
    s_cbranch_scc0 C_nf2
    s_bfe_u32 s65, s60, 0x70011
    s_lshl_b32 s65, s65, 8
    v_add_u32 v28, s65, v20
    ds_read_b32 v236, v28 offset:0
    ds_read_b32 v237, v28 offset:0
    ds_read_b32 v238, v28 offset:0
    ds_read_b32 v239, v28 offset:0
    ds_read_b32 v240, v28 offset:64
    ds_read_b32 v241, v28 offset:64
    ds_read_b32 v242, v28 offset:64
    ds_read_b32 v243, v28 offset:64
    ds_read_b32 v244, v28 offset:128
    ds_read_b32 v245, v28 offset:128
    ds_read_b32 v246, v28 offset:128
    ds_read_b32 v247, v28 offset:128
    ds_read_b32 v248, v28 offset:192
    ds_read_b32 v249, v28 offset:192
    ds_read_b32 v250, v28 offset:192
    ds_read_b32 v251, v28 offset:192
    s_waitcnt lgkmcnt(0)
C_nf2:
    s_bfe_u32 s66, s60, 0x5000c
    v_cmp_gt_u32 s[50:51], s66, v16
    v_cmp_gt_u32 s[52:53], s66, v17
    v_cmp_gt_u32 s[54:55], s66, v18
    v_cmp_gt_u32 s[56:57], s66, v19
    s_waitcnt vmcnt(6)
    v_mfma_f32_16x16x16_bf16 v[172:175], v[168:169], v[128:129], v[236:239]
    v_mfma_f32_16x16x16_bf16 v[176:179], v[168:169], v[130:131], v[240:243]
    v_mfma_f32_16x16x16_bf16 v[180:183], v[168:169], v[132:133], v[244:247]
    v_mfma_f32_16x16x16_bf16 v[184:187], v[168:169], v[134:135], v[248:251]
    v_mfma_f32_16x16x32_bf16 v[188:191], v[160:163], v[96:99], 0
    v_mfma_f32_16x16x32_bf16 v[192:195], v[160:163], v[104:107], 0
    v_mfma_f32_16x16x32_bf16 v[196:199], v[160:163], v[112:115], 0
    v_mfma_f32_16x16x32_bf16 v[200:203], v[160:163], v[120:123], 0
    v_mfma_f32_16x16x32_bf16 v[172:175], v[160:163], v[64:67], v[172:175]
    v_mfma_f32_16x16x32_bf16 v[176:179], v[160:163], v[72:75], v[176:179]
    v_mfma_f32_16x16x32_bf16 v[180:183], v[160:163], v[80:83], v[180:183]
    v_mfma_f32_16x16x32_bf16 v[184:187], v[160:163], v[88:91], v[184:187]
    v_mfma_f32_16x16x32_bf16 v[188:191], v[164:167], v[100:103], v[188:191]
    v_mfma_f32_16x16x32_bf16 v[192:195], v[164:167], v[108:111], v[192:195]
    v_mfma_f32_16x16x32_bf16 v[196:199], v[164:167], v[116:119], v[196:199]
    v_mfma_f32_16x16x32_bf16 v[200:203], v[164:167], v[124:127], v[200:203]
    v_mfma_f32_16x16x32_bf16 v[172:175], v[164:167], v[68:71], v[172:175]
    v_mfma_f32_16x16x32_bf16 v[176:179], v[164:167], v[76:79], v[176:179]
    v_mfma_f32_16x16x32_bf16 v[180:183], v[164:167], v[84:87], v[180:183]
    v_mfma_f32_16x16x32_bf16 v[184:187], v[164:167], v[92:95], v[184:187]
    s_nop 7
    v_mul_f32 v172, 0xbfb8aa3b, v172
    v_mul_f32 v173, 0xbfb8aa3b, v173
    v_mul_f32 v174, 0xbfb8aa3b, v174
    v_mul_f32 v175, 0xbfb8aa3b, v175
    v_mul_f32 v176, 0xbfb8aa3b, v176
    v_mul_f32 v177, 0xbfb8aa3b, v177
    v_mul_f32 v178, 0xbfb8aa3b, v178
    v_mul_f32 v179, 0xbfb8aa3b, v179
    v_mul_f32 v180, 0xbfb8aa3b, v180
    v_mul_f32 v181, 0xbfb8aa3b, v181
    v_mul_f32 v182, 0xbfb8aa3b, v182
    v_mul_f32 v183, 0xbfb8aa3b, v183
    v_mul_f32 v184, 0xbfb8aa3b, v184
    v_mul_f32 v185, 0xbfb8aa3b, v185
    v_mul_f32 v186, 0xbfb8aa3b, v186
    v_mul_f32 v187, 0xbfb8aa3b, v187
    v_exp_f32 v172, v172
    v_exp_f32 v173, v173
    v_exp_f32 v174, v174
    v_exp_f32 v175, v175
    v_exp_f32 v176, v176
    v_exp_f32 v177, v177
    v_exp_f32 v178, v178
    v_exp_f32 v179, v179
    v_exp_f32 v180, v180
    v_exp_f32 v181, v181
    v_exp_f32 v182, v182
    v_exp_f32 v183, v183
    v_exp_f32 v184, v184
    v_exp_f32 v185, v185
    v_exp_f32 v186, v186
    v_exp_f32 v187, v187
    v_add_f32 v172, 1.0, v172
    v_add_f32 v173, 1.0, v173
    v_add_f32 v174, 1.0, v174
    v_add_f32 v175, 1.0, v175
    v_add_f32 v176, 1.0, v176
    v_add_f32 v177, 1.0, v177
    v_add_f32 v178, 1.0, v178
    v_add_f32 v179, 1.0, v179
    v_add_f32 v180, 1.0, v180
    v_add_f32 v181, 1.0, v181
    v_add_f32 v182, 1.0, v182
    v_add_f32 v183, 1.0, v183
    v_add_f32 v184, 1.0, v184
    v_add_f32 v185, 1.0, v185
    v_add_f32 v186, 1.0, v186
    v_add_f32 v187, 1.0, v187
    v_rcp_f32 v172, v172
    v_rcp_f32 v173, v173
    v_rcp_f32 v174, v174
    v_rcp_f32 v175, v175
    v_rcp_f32 v176, v176
    v_rcp_f32 v177, v177
    v_rcp_f32 v178, v178
    v_rcp_f32 v179, v179
    v_rcp_f32 v180, v180
    v_rcp_f32 v181, v181
    v_rcp_f32 v182, v182
    v_rcp_f32 v183, v183
    v_rcp_f32 v184, v184
    v_rcp_f32 v185, v185
    v_rcp_f32 v186, v186
    v_rcp_f32 v187, v187
    s_nop 0
    s_mov_b64 exec, s[50:51]
    v_add_f32 v204, v204, v172
    v_fmac_f32 v220, v172, v188
    v_add_f32 v208, v208, v176
    v_fmac_f32 v224, v176, v192
    v_add_f32 v212, v212, v180
    v_fmac_f32 v228, v180, v196
    v_add_f32 v216, v216, v184
    v_fmac_f32 v232, v184, v200
    s_mov_b64 exec, s[52:53]
    v_add_f32 v205, v205, v173
    v_fmac_f32 v221, v173, v189
    v_add_f32 v209, v209, v177
    v_fmac_f32 v225, v177, v193
    v_add_f32 v213, v213, v181
    v_fmac_f32 v229, v181, v197
    v_add_f32 v217, v217, v185
    v_fmac_f32 v233, v185, v201
    s_mov_b64 exec, s[54:55]
    v_add_f32 v206, v206, v174
    v_fmac_f32 v222, v174, v190
    v_add_f32 v210, v210, v178
    v_fmac_f32 v226, v178, v194
    v_add_f32 v214, v214, v182
    v_fmac_f32 v230, v182, v198
    v_add_f32 v218, v218, v186
    v_fmac_f32 v234, v186, v202
    s_mov_b64 exec, s[56:57]
    v_add_f32 v207, v207, v175
    v_fmac_f32 v223, v175, v191
    v_add_f32 v211, v211, v179
    v_fmac_f32 v227, v179, v195
    v_add_f32 v215, v215, v183
    v_fmac_f32 v231, v183, v199
    v_add_f32 v219, v219, v187
    v_fmac_f32 v235, v187, v203
    s_mov_b64 exec, -1
    s_bitcmp1_b32 s60, 25
    s_cbranch_scc0 C_nl2
    s_bfe_u32 s65, s60, 0x70011
    s_lshl_b32 s65, s65, 9
    v_add_u32 v28, s65, v21
    ds_read_b32 v30, v28 offset:0
    ds_read_b32 v31, v28 offset:64
    ds_read_b32 v32, v28 offset:128
    ds_read_b32 v33, v28 offset:192
    ds_read_b32 v34, v28 offset:256
    ds_read_b32 v35, v28 offset:320
    ds_read_b32 v36, v28 offset:384
    ds_read_b32 v37, v28 offset:448
    v_add_f32 v204, v204, v205
    v_add_f32 v206, v206, v207
    v_add_f32 v208, v208, v209
    v_add_f32 v210, v210, v211
    v_add_f32 v212, v212, v213
    v_add_f32 v214, v214, v215
    v_add_f32 v216, v216, v217
    v_add_f32 v218, v218, v219
    v_add_f32 v220, v220, v221
    v_add_f32 v222, v222, v223
    v_add_f32 v224, v224, v225
    v_add_f32 v226, v226, v227
    v_add_f32 v228, v228, v229
    v_add_f32 v230, v230, v231
    v_add_f32 v232, v232, v233
    v_add_f32 v234, v234, v235
    v_add_f32 v204, v204, v206
    v_add_f32 v208, v208, v210
    v_add_f32 v212, v212, v214
    v_add_f32 v216, v216, v218
    v_add_f32 v220, v220, v222
    v_add_f32 v224, v224, v226
    v_add_f32 v228, v228, v230
    v_add_f32 v232, v232, v234
    v_mov_b32 v205, v204
    v_mov_b32 v209, v208
    v_mov_b32 v213, v212
    v_mov_b32 v217, v216
    v_mov_b32 v221, v220
    v_mov_b32 v225, v224
    v_mov_b32 v229, v228
    v_mov_b32 v233, v232
    s_nop 1
    v_permlane32_swap_b32 v204, v205
    v_permlane32_swap_b32 v208, v209
    v_permlane32_swap_b32 v212, v213
    v_permlane32_swap_b32 v216, v217
    v_permlane32_swap_b32 v220, v221
    v_permlane32_swap_b32 v224, v225
    v_permlane32_swap_b32 v228, v229
    v_permlane32_swap_b32 v232, v233
    v_add_f32 v204, v204, v205
    v_add_f32 v208, v208, v209
    v_add_f32 v212, v212, v213
    v_add_f32 v216, v216, v217
    v_add_f32 v220, v220, v221
    v_add_f32 v224, v224, v225
    v_add_f32 v228, v228, v229
    v_add_f32 v232, v232, v233
    v_mov_b32 v205, v204
    v_mov_b32 v209, v208
    v_mov_b32 v213, v212
    v_mov_b32 v217, v216
    v_mov_b32 v221, v220
    v_mov_b32 v225, v224
    v_mov_b32 v229, v228
    v_mov_b32 v233, v232
    s_nop 1
    v_permlane16_swap_b32 v204, v205
    v_permlane16_swap_b32 v208, v209
    v_permlane16_swap_b32 v212, v213
    v_permlane16_swap_b32 v216, v217
    v_permlane16_swap_b32 v220, v221
    v_permlane16_swap_b32 v224, v225
    v_permlane16_swap_b32 v228, v229
    v_permlane16_swap_b32 v232, v233
    s_waitcnt lgkmcnt(0)
    v_add_f32 v204, v204, v205
    v_add_f32 v204, v204, v30
    v_add_f32 v208, v208, v209
    v_add_f32 v208, v208, v31
    v_add_f32 v212, v212, v213
    v_add_f32 v212, v212, v32
    v_add_f32 v216, v216, v217
    v_add_f32 v216, v216, v33
    v_add_f32 v220, v220, v221
    v_add_f32 v220, v220, v34
    v_add_f32 v224, v224, v225
    v_add_f32 v224, v224, v35
    v_add_f32 v228, v228, v229
    v_add_f32 v228, v228, v36
    v_add_f32 v232, v232, v233
    v_add_f32 v232, v232, v37
    ds_write_b32 v28, v204 offset:0
    ds_write_b32 v28, v208 offset:64
    ds_write_b32 v28, v212 offset:128
    ds_write_b32 v28, v216 offset:192
    ds_write_b32 v28, v220 offset:256
    ds_write_b32 v28, v224 offset:320
    ds_write_b32 v28, v228 offset:384
    ds_write_b32 v28, v232 offset:448
    v_mov_b32 v204, 0
    v_mov_b32 v220, 0
    v_mov_b32 v205, 0
    v_mov_b32 v221, 0
    v_mov_b32 v206, 0
    v_mov_b32 v222, 0
    v_mov_b32 v207, 0
    v_mov_b32 v223, 0
    v_mov_b32 v208, 0
    v_mov_b32 v224, 0
    v_mov_b32 v209, 0
    v_mov_b32 v225, 0
    v_mov_b32 v210, 0
    v_mov_b32 v226, 0
    v_mov_b32 v211, 0
    v_mov_b32 v227, 0
    v_mov_b32 v212, 0
    v_mov_b32 v228, 0
    v_mov_b32 v213, 0
    v_mov_b32 v229, 0
    v_mov_b32 v214, 0
    v_mov_b32 v230, 0
    v_mov_b32 v215, 0
    v_mov_b32 v231, 0
    v_mov_b32 v216, 0
    v_mov_b32 v232, 0
    v_mov_b32 v217, 0
    v_mov_b32 v233, 0
    v_mov_b32 v218, 0
    v_mov_b32 v234, 0
    v_mov_b32 v219, 0
    v_mov_b32 v235, 0
C_nl2:
    s_mov_b32 s60, s61
    s_mov_b32 s61, s62
    s_mov_b32 s62, s67
    s_mov_b32 s67, s68
    s_add_u32 s46, s46, 1
    s_cmp_ge_u32 s46, s44
    s_cbranch_scc1 C_loop_end
    s_branch C_loop
C_loop_end:
    s_waitcnt vmcnt(0) lgkmcnt(0)
    s_barrier
    v_mov_b32 v21, v58
    v_mov_b32 v22, v59
    v_mov_b32 v23, v60
    s_add_u32 s48, s48, 4096
    s_cmp_lt_u32 s48, s47
    s_cbranch_scc1 C_round
    v_mov_b32 v40, 0x358637bd
    s_mov_b32 s54, 25000
    v_add_u32 v5, 0, v0
    v_lshrrev_b32 v6, 5, v5
    v_and_b32 v7, 31, v5
    v_add_u32 v8, s3, v6
    v_cmp_gt_u32 vcc, 98, v6
    v_cmp_gt_u32 s[56:57], s54, v8
    s_and_b64 s[84:85], vcc, s[56:57]
    s_mov_b64 exec, s[84:85]
    v_lshlrev_b32 v9, 9, v6
    v_lshl_add_u32 v9, v7, 3, v9
    ds_read_b64 v[64:65], v9 offset:32768
    ds_read_b64 v[66:67], v9 offset:33024
    v_lshlrev_b32 v9, 8, v6
    v_lshl_add_u32 v9, v7, 3, v9
    v_add_u32 v63, 118784, v9
    ds_read_b64 v[68:69], v63 offset:0
    v_lshlrev_b32 v71, 7, v8
    v_lshl_add_u32 v71, v7, 2, v71
    buffer_load_dword v70, v71, s[12:15], 0 offen
    s_mov_b64 exec, -1
    v_add_u32 v5, 512, v0
    v_lshrrev_b32 v6, 5, v5
    v_and_b32 v7, 31, v5
    v_add_u32 v8, s3, v6
    v_cmp_gt_u32 vcc, 98, v6
    v_cmp_gt_u32 s[56:57], s54, v8
    s_and_b64 s[86:87], vcc, s[56:57]
    s_mov_b64 exec, s[86:87]
    v_lshlrev_b32 v9, 9, v6
    v_lshl_add_u32 v9, v7, 3, v9
    ds_read_b64 v[74:75], v9 offset:32768
    ds_read_b64 v[76:77], v9 offset:33024
    v_lshlrev_b32 v9, 8, v6
    v_lshl_add_u32 v9, v7, 3, v9
    v_add_u32 v63, 118784, v9
    ds_read_b64 v[78:79], v63 offset:0
    v_lshlrev_b32 v81, 7, v8
    v_lshl_add_u32 v81, v7, 2, v81
    buffer_load_dword v80, v81, s[12:15], 0 offen
    s_mov_b64 exec, -1
    v_add_u32 v5, 1024, v0
    v_lshrrev_b32 v6, 5, v5
    v_and_b32 v7, 31, v5
    v_add_u32 v8, s3, v6
    v_cmp_gt_u32 vcc, 98, v6
    v_cmp_gt_u32 s[56:57], s54, v8
    s_and_b64 s[88:89], vcc, s[56:57]
    s_mov_b64 exec, s[88:89]
    v_lshlrev_b32 v9, 9, v6
    v_lshl_add_u32 v9, v7, 3, v9
    ds_read_b64 v[84:85], v9 offset:32768
    ds_read_b64 v[86:87], v9 offset:33024
    v_lshlrev_b32 v9, 8, v6
    v_lshl_add_u32 v9, v7, 3, v9
    v_add_u32 v63, 118784, v9
    ds_read_b64 v[88:89], v63 offset:0
    v_lshlrev_b32 v91, 7, v8
    v_lshl_add_u32 v91, v7, 2, v91
    buffer_load_dword v90, v91, s[12:15], 0 offen
    s_mov_b64 exec, -1
    v_add_u32 v5, 1536, v0
    v_lshrrev_b32 v6, 5, v5
    v_and_b32 v7, 31, v5
    v_add_u32 v8, s3, v6
    v_cmp_gt_u32 vcc, 98, v6
    v_cmp_gt_u32 s[56:57], s54, v8
    s_and_b64 s[90:91], vcc, s[56:57]
    s_mov_b64 exec, s[90:91]
    v_lshlrev_b32 v9, 9, v6
    v_lshl_add_u32 v9, v7, 3, v9
    ds_read_b64 v[94:95], v9 offset:32768
    ds_read_b64 v[96:97], v9 offset:33024
    v_lshlrev_b32 v9, 8, v6
    v_lshl_add_u32 v9, v7, 3, v9
    v_add_u32 v63, 118784, v9
    ds_read_b64 v[98:99], v63 offset:0
    v_lshlrev_b32 v101, 7, v8
    v_lshl_add_u32 v101, v7, 2, v101
    buffer_load_dword v100, v101, s[12:15], 0 offen
    s_mov_b64 exec, -1
    v_add_u32 v5, 2048, v0
    v_lshrrev_b32 v6, 5, v5
    v_and_b32 v7, 31, v5
    v_add_u32 v8, s3, v6
    v_cmp_gt_u32 vcc, 98, v6
    v_cmp_gt_u32 s[56:57], s54, v8
    s_and_b64 s[92:93], vcc, s[56:57]
    s_mov_b64 exec, s[92:93]
    v_lshlrev_b32 v9, 9, v6
    v_lshl_add_u32 v9, v7, 3, v9
    ds_read_b64 v[104:105], v9 offset:32768
    ds_read_b64 v[106:107], v9 offset:33024
    v_lshlrev_b32 v9, 8, v6
    v_lshl_add_u32 v9, v7, 3, v9
    v_add_u32 v63, 118784, v9
    ds_read_b64 v[108:109], v63 offset:0
    v_lshlrev_b32 v111, 7, v8
    v_lshl_add_u32 v111, v7, 2, v111
    buffer_load_dword v110, v111, s[12:15], 0 offen
    s_mov_b64 exec, -1
    v_add_u32 v5, 2560, v0
    v_lshrrev_b32 v6, 5, v5
    v_and_b32 v7, 31, v5
    v_add_u32 v8, s3, v6
    v_cmp_gt_u32 vcc, 98, v6
    v_cmp_gt_u32 s[56:57], s54, v8
    s_and_b64 s[94:95], vcc, s[56:57]
    s_mov_b64 exec, s[94:95]
    v_lshlrev_b32 v9, 9, v6
    v_lshl_add_u32 v9, v7, 3, v9
    ds_read_b64 v[114:115], v9 offset:32768
    ds_read_b64 v[116:117], v9 offset:33024
    v_lshlrev_b32 v9, 8, v6
    v_lshl_add_u32 v9, v7, 3, v9
    v_add_u32 v63, 118784, v9
    ds_read_b64 v[118:119], v63 offset:0
    v_lshlrev_b32 v121, 7, v8
    v_lshl_add_u32 v121, v7, 2, v121
    buffer_load_dword v120, v121, s[12:15], 0 offen
    s_mov_b64 exec, -1
    v_add_u32 v5, 3072, v0
    v_lshrrev_b32 v6, 5, v5
    v_and_b32 v7, 31, v5
    v_add_u32 v8, s3, v6
    v_cmp_gt_u32 vcc, 98, v6
    v_cmp_gt_u32 s[56:57], s54, v8
    s_and_b64 s[96:97], vcc, s[56:57]
    s_mov_b64 exec, s[96:97]
    v_lshlrev_b32 v9, 9, v6
    v_lshl_add_u32 v9, v7, 3, v9
    ds_read_b64 v[124:125], v9 offset:32768
    ds_read_b64 v[126:127], v9 offset:33024
    v_lshlrev_b32 v9, 8, v6
    v_lshl_add_u32 v9, v7, 3, v9
    v_add_u32 v63, 118784, v9
    ds_read_b64 v[128:129], v63 offset:0
    v_lshlrev_b32 v131, 7, v8
    v_lshl_add_u32 v131, v7, 2, v131
    buffer_load_dword v130, v131, s[12:15], 0 offen
    s_mov_b64 exec, -1
    s_waitcnt vmcnt(0) lgkmcnt(0)
    s_mov_b64 exec, s[84:85]
    v_add_f32 v64, v40, v64
    v_rcp_f32 v64, v64
    s_nop 0
    v_fma_f32 v68, v66, v64, v68
    v_add_f32 v65, v40, v65
    v_rcp_f32 v65, v65
    s_nop 0
    v_fma_f32 v69, v67, v65, v69
    v_cvt_pk_bf16_f32 v68, v68, v69
    v_lshlrev_b32 v64, 16, v68
    v_and_b32 v65, 0xffff0000, v68
    v_max_f32 v64, 0, v64
    v_max_f32 v65, 0, v65
    v_lshlrev_b32 v66, 16, v70
    v_and_b32 v67, 0xffff0000, v70
    v_add_f32 v64, v64, v66
    v_add_f32 v65, v65, v67
    v_cvt_pk_bf16_f32 v64, v64, v65
    buffer_store_dword v64, v71, s[20:23], 0 offen
    s_mov_b64 exec, s[86:87]
    v_add_f32 v74, v40, v74
    v_rcp_f32 v74, v74
    s_nop 0
    v_fma_f32 v78, v76, v74, v78
    v_add_f32 v75, v40, v75
    v_rcp_f32 v75, v75
    s_nop 0
    v_fma_f32 v79, v77, v75, v79
    v_cvt_pk_bf16_f32 v78, v78, v79
    v_lshlrev_b32 v74, 16, v78
    v_and_b32 v75, 0xffff0000, v78
    v_max_f32 v74, 0, v74
    v_max_f32 v75, 0, v75
    v_lshlrev_b32 v76, 16, v80
    v_and_b32 v77, 0xffff0000, v80
    v_add_f32 v74, v74, v76
    v_add_f32 v75, v75, v77
    v_cvt_pk_bf16_f32 v74, v74, v75
    buffer_store_dword v74, v81, s[20:23], 0 offen
    s_mov_b64 exec, s[88:89]
    v_add_f32 v84, v40, v84
    v_rcp_f32 v84, v84
    s_nop 0
    v_fma_f32 v88, v86, v84, v88
    v_add_f32 v85, v40, v85
    v_rcp_f32 v85, v85
    s_nop 0
    v_fma_f32 v89, v87, v85, v89
    v_cvt_pk_bf16_f32 v88, v88, v89
    v_lshlrev_b32 v84, 16, v88
    v_and_b32 v85, 0xffff0000, v88
    v_max_f32 v84, 0, v84
    v_max_f32 v85, 0, v85
    v_lshlrev_b32 v86, 16, v90
    v_and_b32 v87, 0xffff0000, v90
    v_add_f32 v84, v84, v86
    v_add_f32 v85, v85, v87
    v_cvt_pk_bf16_f32 v84, v84, v85
    buffer_store_dword v84, v91, s[20:23], 0 offen
    s_mov_b64 exec, s[90:91]
    v_add_f32 v94, v40, v94
    v_rcp_f32 v94, v94
    s_nop 0
    v_fma_f32 v98, v96, v94, v98
    v_add_f32 v95, v40, v95
    v_rcp_f32 v95, v95
    s_nop 0
    v_fma_f32 v99, v97, v95, v99
    v_cvt_pk_bf16_f32 v98, v98, v99
    v_lshlrev_b32 v94, 16, v98
    v_and_b32 v95, 0xffff0000, v98
    v_max_f32 v94, 0, v94
    v_max_f32 v95, 0, v95
    v_lshlrev_b32 v96, 16, v100
    v_and_b32 v97, 0xffff0000, v100
    v_add_f32 v94, v94, v96
    v_add_f32 v95, v95, v97
    v_cvt_pk_bf16_f32 v94, v94, v95
    buffer_store_dword v94, v101, s[20:23], 0 offen
    s_mov_b64 exec, s[92:93]
    v_add_f32 v104, v40, v104
    v_rcp_f32 v104, v104
    s_nop 0
    v_fma_f32 v108, v106, v104, v108
    v_add_f32 v105, v40, v105
    v_rcp_f32 v105, v105
    s_nop 0
    v_fma_f32 v109, v107, v105, v109
    v_cvt_pk_bf16_f32 v108, v108, v109
    v_lshlrev_b32 v104, 16, v108
    v_and_b32 v105, 0xffff0000, v108
    v_max_f32 v104, 0, v104
    v_max_f32 v105, 0, v105
    v_lshlrev_b32 v106, 16, v110
    v_and_b32 v107, 0xffff0000, v110
    v_add_f32 v104, v104, v106
    v_add_f32 v105, v105, v107
    v_cvt_pk_bf16_f32 v104, v104, v105
    buffer_store_dword v104, v111, s[20:23], 0 offen
    s_mov_b64 exec, s[94:95]
    v_add_f32 v114, v40, v114
    v_rcp_f32 v114, v114
    s_nop 0
    v_fma_f32 v118, v116, v114, v118
    v_add_f32 v115, v40, v115
    v_rcp_f32 v115, v115
    s_nop 0
    v_fma_f32 v119, v117, v115, v119
    v_cvt_pk_bf16_f32 v118, v118, v119
    v_lshlrev_b32 v114, 16, v118
    v_and_b32 v115, 0xffff0000, v118
    v_max_f32 v114, 0, v114
    v_max_f32 v115, 0, v115
    v_lshlrev_b32 v116, 16, v120
    v_and_b32 v117, 0xffff0000, v120
    v_add_f32 v114, v114, v116
    v_add_f32 v115, v115, v117
    v_cvt_pk_bf16_f32 v114, v114, v115
    buffer_store_dword v114, v121, s[20:23], 0 offen
    s_mov_b64 exec, s[96:97]
    v_add_f32 v124, v40, v124
    v_rcp_f32 v124, v124
    s_nop 0
    v_fma_f32 v128, v126, v124, v128
    v_add_f32 v125, v40, v125
    v_rcp_f32 v125, v125
    s_nop 0
    v_fma_f32 v129, v127, v125, v129
    v_cvt_pk_bf16_f32 v128, v128, v129
    v_lshlrev_b32 v124, 16, v128
    v_and_b32 v125, 0xffff0000, v128
    v_max_f32 v124, 0, v124
    v_max_f32 v125, 0, v125
    v_lshlrev_b32 v126, 16, v130
    v_and_b32 v127, 0xffff0000, v130
    v_add_f32 v124, v124, v126
    v_add_f32 v125, v125, v127
    v_cvt_pk_bf16_f32 v124, v124, v125
    buffer_store_dword v124, v131, s[20:23], 0 offen
    s_mov_b64 exec, -1
C_end:
    s_endpgm
.section .rodata,"a"
.p2align 6
.amdhsa_kernel gcn_part_kernel
  .amdhsa_next_free_vgpr 96
  .amdhsa_next_free_sgpr 64
  .amdhsa_accum_offset 96
  .amdhsa_group_segment_fixed_size 0
  .amdhsa_kernarg_size 96
  .amdhsa_user_sgpr_count 2
  .amdhsa_user_sgpr_kernarg_segment_ptr 1
  .amdhsa_system_sgpr_workgroup_id_x 1
.end_amdhsa_kernel

.p2align 6
.amdhsa_kernel standalone__edge_featured_mpnn_gatedgcn__graph_kernel
  .amdhsa_next_free_vgpr 256
  .amdhsa_next_free_sgpr 100
  .amdhsa_accum_offset 256
  .amdhsa_group_segment_fixed_size 0
  .amdhsa_kernarg_size 96
  .amdhsa_user_sgpr_count 2
  .amdhsa_user_sgpr_kernarg_segment_ptr 1
  .amdhsa_system_sgpr_workgroup_id_x 1
.end_amdhsa_kernel
```
